```python
import torch

def _softmax(x, axis=-1):
    return torch.softmax(x, dim=axis)
def _gelu(x):
    return torch.nn.functional.gelu(x, approximate="tanh")
def _silu(x):
    return torch.nn.functional.silu(x)
def _sigmoid(x):
    return torch.sigmoid(x)
def _layernorm(x, axis=-1, eps=1e-5):
    m = x.mean(dim=axis, keepdim=True)
    v = x.var(dim=axis, keepdim=True, unbiased=False)
    return (x - m) / torch.sqrt(v + eps)
def _scatter_add(tgt, idx, src, axis=0):
    return tgt.clone().index_add_(axis, idx, src)
def _segment_sum(src, seg, n):
    out = torch.zeros((n,) + src.shape[1:], dtype=src.dtype)
    return out.index_add_(0, seg, src)
def _pad(x, pw):
    flat = tuple(v for pair in reversed(pw) for v in pair)
    return torch.nn.functional.pad(x, flat)

kernel_name = 'sequential_preLN__mha_block_cached__geglu_ffn__decode'

def setup_inputs():

    _w = (lambda a: (lambda t: t.to(torch.bfloat16) if t.is_floating_point() else t)(torch.as_tensor(a)))
    def _A_setup():
        B, Sq, D = 2, 1, 640
        H, Sk, Dh = 32, 16384, 192
        return {
            "x": _w((lambda *s: torch.randn(*s, dtype=torch.bfloat16) * 0.05)(B, Sq, D)),
            "k_cache": _w((lambda *s: torch.randn(*s, dtype=torch.bfloat16) * 3.2)(B, H, Sk, Dh)),
            "v_cache": _w((lambda *s: torch.randn(*s, dtype=torch.bfloat16) * 0.4)(B, H, Sk, Dh)),
            "wq": _w((lambda *s: torch.randn(*s, dtype=torch.bfloat16) * 3.2)(D, H * Dh) * (D ** -0.5)),
            "wo": _w((lambda *s: torch.randn(*s, dtype=torch.bfloat16) * 0.4)(H * Dh, D) * ((H * Dh) ** -0.5)),
        }
    _A_in = _A_setup()

    def _B_setup():
        B, S, D, F = 2, 1, 640, 1536
        return {
            "x": _w((lambda *s: torch.randn(*s, dtype=torch.bfloat16) * 0.05)(B, S, D)),
            "w_gate": _w((lambda *s: torch.randn(*s, dtype=torch.bfloat16) * 0.05)(D, F)),
            "w_up": _w((lambda *s: torch.randn(*s, dtype=torch.bfloat16) * 0.05)(D, F)),
            "w_down": _w((lambda *s: torch.randn(*s, dtype=torch.bfloat16) * 0.05)(F, D)),
        }
    _B_in = _B_setup()

    return {
        "A_x": _A_in["x"],
        "A_k_cache": _A_in["k_cache"],
        "A_v_cache": _A_in["v_cache"],
        "A_wq": _A_in["wq"],
        "A_wo": _A_in["wo"],
        "B_x": _B_in["x"],
        "B_w_gate": _B_in["w_gate"],
        "B_w_up": _B_in["w_up"],
        "B_w_down": _B_in["w_down"],
    }

def reference(A_x, A_k_cache, A_v_cache, A_wq, A_wo, B_x, B_w_gate, B_w_up, B_w_down):
    def _A_ref(x, k_cache, v_cache, wq, wo):
        B, Sq, D = x.shape
        H, Dh = 32, 192
        q = (lambda x, *d: x.permute(*d))((x @ wq).reshape(B, Sq, H, Dh), 0, 2, 1, 3)
        scores = torch.einsum("bhqd,bhkd->bhqk", q, k_cache) * (Dh ** -0.5)
        p = _softmax(scores, axis=-1)
        o = torch.einsum("bhqk,bhkd->bhqd", p, v_cache)
        return (lambda x, *d: x.permute(*d))(o, 0, 2, 1, 3).reshape(B, Sq, H * Dh) @ wo

    def _B_ref(x, w_gate, w_up, w_down):
        return (_gelu(x @ w_gate) * (x @ w_up)) @ w_down

    x = A_x
    h = x + _A_ref(_layernorm(x, axis=-1), A_k_cache, A_v_cache, A_wq, A_wo)
    h2 = h + _B_ref(_layernorm(h, axis=-1), B_w_gate, B_w_up, B_w_down)
    return h2
```

```asm
; @launch grid=(256,1,1) block=(512,1,1) lds=144384
.amdgcn_target "amdgcn-amd-amdhsa--gfx950"
.text
.globl sequential_preLN__mha_block_cached__geglu_ffn__decode_kernel
.p2align 8
.type sequential_preLN__mha_block_cached__geglu_ffn__decode_kernel,@function
sequential_preLN__mha_block_cached__geglu_ffn__decode_kernel:
    s_cmp_ge_u32 s2, 256
    s_cbranch_scc1 L_end
    s_load_dwordx16 s[16:31], s[0:1], 0
    s_load_dwordx8 s[32:39], s[0:1], 64
    v_lshrrev_b32 v2, 6, v0
    v_and_b32 v1, 63, v0
    v_readfirstlane_b32 s3, v2
    s_lshr_b32 s4, s2, 3
    s_and_b32 s5, s2, 7
    s_add_u32 s6, s5, s4
    s_and_b32 s6, s6, 7
    s_mov_b32 s59, 0x3fb8aa3b
    s_cmp_ge_u32 s3, 4
    s_cbranch_scc1 L_service
    v_lshrrev_b32 v48, 4, v1
    v_bfe_u32 v49, v1, 2, 2
    v_mul_u32_u24 v2, 768, v49
    v_lshl_add_u32 v2, v48, 6, v2
    v_and_b32 v49, 3, v1
    v_lshl_add_u32 v2, v49, 4, v2
    s_mov_b32 s67, s5
    s_mul_i32 s75, s67, 192
    s_lshl_b32 s67, s67, 9
    s_mov_b32 s8, s4
    s_lshl_b32 s8, s8, 2
    s_add_u32 s8, s8, s3
    s_add_u32 s75, s75, s8
    s_mov_b32 s8, 0
    s_lshr_b32 s10, s8, 7
    s_lshl_b32 s10, s10, 12
    s_add_u32 s10, s10, s67
    s_and_b32 s50, s8, 96
    s_lshl_b32 s50, s50, 2
    s_add_u32 s50, s50, s75
    s_and_b32 s50, s50, 511
    s_add_u32 s50, s50, s10
    s_mul_i32 s9, s50, 12288
    s_waitcnt lgkmcnt(0)
    s_mov_b32 s40, s18
    s_mov_b32 s41, s19
    s_mov_b32 s42, 402653184
    s_mov_b32 s43, 0x00020000
    s_barrier
    buffer_load_dwordx4 v[64:67], v2, s[40:43], s9 offen offset:0 nt
    buffer_load_dwordx4 v[68:71], v2, s[40:43], s9 offen offset:256 nt
    buffer_load_dwordx4 v[72:75], v2, s[40:43], s9 offen offset:512 nt
    s_add_u32 s13, s9, 3072
    buffer_load_dwordx4 v[76:79], v2, s[40:43], s13 offen offset:0 nt
    buffer_load_dwordx4 v[80:83], v2, s[40:43], s13 offen offset:256 nt
    buffer_load_dwordx4 v[84:87], v2, s[40:43], s13 offen offset:512 nt
    s_add_u32 s13, s9, 6144
    buffer_load_dwordx4 v[88:91], v2, s[40:43], s13 offen offset:0 nt
    buffer_load_dwordx4 v[92:95], v2, s[40:43], s13 offen offset:256 nt
    buffer_load_dwordx4 v[96:99], v2, s[40:43], s13 offen offset:512 nt
    s_mov_b32 s44, s20
    s_mov_b32 s45, s21
    s_mov_b32 s46, 402653184
    s_mov_b32 s47, 0x00020000
    s_mov_b32 s76, s18
    s_mov_b32 s77, s19
    s_mov_b32 s78, 402653184
    s_mov_b32 s79, 0x00020000
    s_mov_b32 s68, s38
    s_mov_b32 s69, s39
    s_mov_b32 s70, 5242880
    s_mov_b32 s71, 0x00020000
    v_mul_u32_u24 v3, 768, v48
    v_and_b32 v49, 15, v1
    v_lshl_add_u32 v3, v49, 4, v3
    v_and_b32 v49, 1, v1
    v_mov_b32 v50, 0xffff
    v_lshlrev_b32 v49, 4, v49
    v_lshlrev_b32 v50, v49, v50
    v_bfe_u32 v49, v1, 1, 2
    v_cmp_eq_u32 vcc, 0, v49
    s_nop 1
    v_cndmask_b32 v4, 0, v50, vcc
    v_cmp_eq_u32 vcc, 1, v49
    s_nop 1
    v_cndmask_b32 v5, 0, v50, vcc
    v_cmp_eq_u32 vcc, 2, v49
    s_nop 1
    v_cndmask_b32 v6, 0, v50, vcc
    v_cmp_eq_u32 vcc, 3, v49
    s_nop 1
    v_cndmask_b32 v7, 0, v50, vcc
    s_mul_i32 s10, s3, 3072
    s_add_u32 s10, s10, 46080
    v_lshl_add_u32 v55, v1, 4, s10
    s_lshl_b32 s10, s3, 12
    s_add_u32 s10, s10, 29696
    v_lshrrev_b32 v54, 3, v1
    v_lshl_add_u32 v54, v54, 3, s10
    s_mov_b32 s58, 0x3d93cd3a
    s_mov_b32 s60, 0x01010101
    s_mov_b32 s61, 0x01010101
    s_lshl_b32 s10, s4, 8
    s_add_u32 s48, s38, s10
    s_addc_u32 s49, s39, 0
    s_mov_b32 s56, -1
    v_mov_b32 v20, 0
    v_mov_b32 v21, 0
    v_mov_b32 v22, 0
    v_mov_b32 v23, 0
    v_mov_b32 v24, 0
    v_mov_b32 v25, 0
    v_mov_b32 v26, 0
    v_mov_b32 v27, 0
    v_mov_b32 v28, 0
    v_mov_b32 v29, 0
    v_mov_b32 v30, 0
    v_mov_b32 v31, 0
    v_and_b32 v49, 3, v1
    v_lshlrev_b32 v49, 4, v49
    v_lshl_add_u32 v48, v48, 6, v49
    v_bfe_u32 v49, v1, 3, 1
    v_mul_u32_u24 v49, 384, v49
    v_sub_u32 v48, v48, v49
    v_mov_b32 v50, 48
    v_add_u32 v49, 0, v48
    v_cmp_gt_u32 vcc, 384, v49
    v_add_u32 v49, 26368, v49
    s_nop 0
    v_cndmask_b32 v56, v50, v49, vcc
    v_cndmask_b32 v59, 0, 1, vcc
    v_add_u32 v49, 256, v48
    v_cmp_gt_u32 vcc, 384, v49
    v_add_u32 v49, 26368, v49
    s_nop 0
    v_cndmask_b32 v57, v50, v49, vcc
    v_cndmask_b32 v60, 0, 1, vcc
    v_add_u32 v49, 512, v48
    v_cmp_gt_u32 vcc, 384, v49
    v_add_u32 v49, 26368, v49
    s_nop 0
    v_cndmask_b32 v58, v50, v49, vcc
    v_cndmask_b32 v61, 0, 1, vcc
    s_mov_b32 s64, s5
    s_mul_i32 s64, s64, 35840
    s_add_u32 s64, s64, 3145728
    s_mov_b32 s100, s4
    s_waitcnt vmcnt(6)
    s_add_u32 s13, s9, 9216
    buffer_load_dwordx4 v[100:103], v2, s[40:43], s13 offen offset:0 nt
    buffer_load_dwordx4 v[104:107], v2, s[40:43], s13 offen offset:256 nt
    buffer_load_dwordx4 v[108:111], v2, s[40:43], s13 offen offset:512 nt
    s_add_u32 s11, s8, 32
    s_lshr_b32 s10, s11, 7
    s_lshl_b32 s10, s10, 12
    s_add_u32 s10, s10, s67
    s_and_b32 s51, s11, 96
    s_lshl_b32 s51, s51, 2
    s_add_u32 s51, s51, s75
    s_and_b32 s51, s51, 511
    s_add_u32 s51, s51, s10
    s_mul_i32 s9, s51, 12288
    s_waitcnt vmcnt(6)
    buffer_load_dwordx4 v[112:115], v2, s[40:43], s9 offen offset:0 nt
    buffer_load_dwordx4 v[116:119], v2, s[40:43], s9 offen offset:256 nt
    buffer_load_dwordx4 v[120:123], v2, s[40:43], s9 offen offset:512 nt
    s_waitcnt vmcnt(6)
    s_add_u32 s13, s9, 3072
    buffer_load_dwordx4 v[124:127], v2, s[40:43], s13 offen offset:0 nt
    buffer_load_dwordx4 v[128:131], v2, s[40:43], s13 offen offset:256 nt
    buffer_load_dwordx4 v[132:135], v2, s[40:43], s13 offen offset:512 nt
    s_waitcnt vmcnt(6)
    s_add_u32 s13, s9, 6144
    buffer_load_dwordx4 v[136:139], v2, s[40:43], s13 offen offset:0 nt
    buffer_load_dwordx4 v[140:143], v2, s[40:43], s13 offen offset:256 nt
    buffer_load_dwordx4 v[144:147], v2, s[40:43], s13 offen offset:512 nt
    s_waitcnt vmcnt(6)
    s_add_u32 s13, s9, 9216
    buffer_load_dwordx4 v[148:151], v2, s[40:43], s13 offen offset:0 nt
    buffer_load_dwordx4 v[152:155], v2, s[40:43], s13 offen offset:256 nt
    buffer_load_dwordx4 v[156:159], v2, s[40:43], s13 offen offset:512 nt
    s_add_u32 s11, s8, 64
    s_lshr_b32 s10, s11, 7
    s_lshl_b32 s10, s10, 12
    s_add_u32 s10, s10, s67
    s_and_b32 s53, s11, 96
    s_lshl_b32 s53, s53, 2
    s_add_u32 s53, s53, s75
    s_and_b32 s53, s53, 511
    s_add_u32 s53, s53, s10
    s_mul_i32 s9, s53, 12288
    s_waitcnt vmcnt(6)
    buffer_load_dwordx4 v[160:163], v2, s[40:43], s9 offen offset:0 nt
    buffer_load_dwordx4 v[164:167], v2, s[40:43], s9 offen offset:256 nt
    buffer_load_dwordx4 v[168:171], v2, s[40:43], s9 offen offset:512 nt
    s_waitcnt vmcnt(6)
    s_add_u32 s13, s9, 3072
    buffer_load_dwordx4 v[172:175], v2, s[40:43], s13 offen offset:0 nt
    buffer_load_dwordx4 v[176:179], v2, s[40:43], s13 offen offset:256 nt
    buffer_load_dwordx4 v[180:183], v2, s[40:43], s13 offen offset:512 nt
    s_waitcnt vmcnt(9)
    s_add_u32 s13, s9, 6144
    buffer_load_dwordx4 v[184:187], v2, s[40:43], s13 offen offset:0 nt
    buffer_load_dwordx4 v[188:191], v2, s[40:43], s13 offen offset:256 nt
    buffer_load_dwordx4 v[192:195], v2, s[40:43], s13 offen offset:512 nt
    s_waitcnt vmcnt(9)
    s_add_u32 s13, s9, 9216
    buffer_load_dwordx4 v[196:199], v2, s[40:43], s13 offen offset:0 nt
    buffer_load_dwordx4 v[200:203], v2, s[40:43], s13 offen offset:256 nt
    buffer_load_dwordx4 v[204:207], v2, s[40:43], s13 offen offset:512 nt
    s_add_u32 s11, s8, 96
    s_lshr_b32 s10, s11, 7
    s_lshl_b32 s10, s10, 12
    s_add_u32 s10, s10, s67
    s_and_b32 s54, s11, 96
    s_lshl_b32 s54, s54, 2
    s_add_u32 s54, s54, s75
    s_and_b32 s54, s54, 511
    s_add_u32 s54, s54, s10
    s_mul_i32 s9, s54, 12288
    s_waitcnt vmcnt(9)
    buffer_load_dwordx4 v[208:211], v2, s[40:43], s9 offen offset:0 nt
    buffer_load_dwordx4 v[212:215], v2, s[40:43], s9 offen offset:256 nt
    buffer_load_dwordx4 v[216:219], v2, s[40:43], s9 offen offset:512 nt
    s_waitcnt vmcnt(9)
    s_add_u32 s13, s9, 3072
    buffer_load_dwordx4 v[220:223], v2, s[40:43], s13 offen offset:0 nt
    buffer_load_dwordx4 v[224:227], v2, s[40:43], s13 offen offset:256 nt
    buffer_load_dwordx4 v[228:231], v2, s[40:43], s13 offen offset:512 nt
    s_waitcnt vmcnt(9)
    s_add_u32 s13, s9, 6144
    buffer_load_dwordx4 v[232:235], v2, s[40:43], s13 offen offset:0 nt
    buffer_load_dwordx4 v[236:239], v2, s[40:43], s13 offen offset:256 nt
    buffer_load_dwordx4 v[240:243], v2, s[40:43], s13 offen offset:512 nt
    s_waitcnt vmcnt(9)
    s_add_u32 s13, s9, 9216
    buffer_load_dwordx4 v[244:247], v2, s[40:43], s13 offen offset:0 nt
    buffer_load_dwordx4 v[248:251], v2, s[40:43], s13 offen offset:256 nt
    buffer_load_dwordx4 v[252:255], v2, s[40:43], s13 offen offset:512 nt
    s_mul_i32 s12, s3, 3072
    s_mov_b32 s10, 0
L_qs_f:
    s_lshl_b32 s11, s10, 2
    v_mov_b32 v48, s11
    s_mov_b32 s14, 2097152
L_ql_f:
    ds_read_b32 v49, v48 offset:96
    s_waitcnt lgkmcnt(0)
    v_cmp_ne_u32 vcc, 0, v49
    s_cbranch_vccnz L_qok_f
    s_sleep 1
    s_sub_u32 s14, s14, 1
    s_cbranch_scc0 L_ql_f
L_qok_f:
    s_mov_b32 s56, s10
    s_mul_i32 s11, s10, 384
    v_mad_u32_u24 v48, v59, s11, v56
    v_mad_u32_u24 v49, v60, s11, v57
    v_mad_u32_u24 v50, v61, s11, v58
    ds_read_b128 v[8:11], v48
    ds_read_b128 v[12:15], v49
    ds_read_b128 v[16:19], v50
    s_waitcnt lgkmcnt(0)
    s_sub_u32 s55, s8, 736
    s_add_u32 s11, s8, 128
    s_lshr_b32 s10, s11, 7
    s_lshl_b32 s10, s10, 12
    s_add_u32 s10, s10, s67
    s_and_b32 s52, s11, 96
    s_lshl_b32 s52, s52, 2
    s_add_u32 s52, s52, s75
    s_and_b32 s52, s52, 511
    s_add_u32 s52, s52, s10
    s_mul_i32 s9, s52, 12288
    s_waitcnt vmcnt(45)
    v_mfma_f32_16x16x32_bf16 v[32:35], v[64:67], v[8:11], 0
    v_mfma_f32_16x16x32_bf16 v[32:35], v[68:71], v[12:15], v[32:35]
    v_mfma_f32_16x16x32_bf16 v[32:35], v[72:75], v[16:19], v[32:35]
    s_waitcnt vmcnt(42)
    v_mfma_f32_16x16x32_bf16 v[36:39], v[76:79], v[8:11], 0
    v_mfma_f32_16x16x32_bf16 v[36:39], v[80:83], v[12:15], v[36:39]
    v_mfma_f32_16x16x32_bf16 v[36:39], v[84:87], v[16:19], v[36:39]
    buffer_load_dwordx4 v[64:67], v2, s[40:43], s9 offen offset:0 nt
    buffer_load_dwordx4 v[68:71], v2, s[40:43], s9 offen offset:256 nt
    buffer_load_dwordx4 v[72:75], v2, s[40:43], s9 offen offset:512 nt
    s_waitcnt vmcnt(42)
    v_mfma_f32_16x16x32_bf16 v[40:43], v[88:91], v[8:11], 0
    v_mfma_f32_16x16x32_bf16 v[40:43], v[92:95], v[12:15], v[40:43]
    v_mfma_f32_16x16x32_bf16 v[40:43], v[96:99], v[16:19], v[40:43]
    s_add_u32 s13, s9, 3072
    buffer_load_dwordx4 v[76:79], v2, s[40:43], s13 offen offset:0 nt
    s_add_u32 s13, s9, 3072
    buffer_load_dwordx4 v[80:83], v2, s[40:43], s13 offen offset:256 nt
    s_add_u32 s13, s9, 3072
    buffer_load_dwordx4 v[84:87], v2, s[40:43], s13 offen offset:512 nt
    s_waitcnt vmcnt(42)
    v_mfma_f32_16x16x32_bf16 v[44:47], v[100:103], v[8:11], 0
    v_mfma_f32_16x16x32_bf16 v[44:47], v[104:107], v[12:15], v[44:47]
    v_mfma_f32_16x16x32_bf16 v[44:47], v[108:111], v[16:19], v[44:47]
    v_mov_b32_dpp v48, v32 quad_perm:[0,0,0,0] row_mask:0xf bank_mask:0xf
    v_add_f32_dpp v48, v33, v48 quad_perm:[1,1,1,1] row_mask:0xf bank_mask:0xf
    v_add_f32_dpp v48, v34, v48 quad_perm:[2,2,2,2] row_mask:0xf bank_mask:0xf
    v_add_f32_dpp v48, v35, v48 quad_perm:[3,3,3,3] row_mask:0xf bank_mask:0xf
    v_mov_b32_dpp v49, v36 quad_perm:[0,0,0,0] row_mask:0xf bank_mask:0xf
    v_add_f32_dpp v49, v37, v49 quad_perm:[1,1,1,1] row_mask:0xf bank_mask:0xf
    v_add_f32_dpp v49, v38, v49 quad_perm:[2,2,2,2] row_mask:0xf bank_mask:0xf
    v_add_f32_dpp v49, v39, v49 quad_perm:[3,3,3,3] row_mask:0xf bank_mask:0xf
    v_mov_b32_dpp v50, v40 quad_perm:[0,0,0,0] row_mask:0xf bank_mask:0xf
    v_add_f32_dpp v50, v41, v50 quad_perm:[1,1,1,1] row_mask:0xf bank_mask:0xf
    v_add_f32_dpp v50, v42, v50 quad_perm:[2,2,2,2] row_mask:0xf bank_mask:0xf
    v_add_f32_dpp v50, v43, v50 quad_perm:[3,3,3,3] row_mask:0xf bank_mask:0xf
    v_mov_b32_dpp v51, v44 quad_perm:[0,0,0,0] row_mask:0xf bank_mask:0xf
    v_add_f32_dpp v51, v45, v51 quad_perm:[1,1,1,1] row_mask:0xf bank_mask:0xf
    v_add_f32_dpp v51, v46, v51 quad_perm:[2,2,2,2] row_mask:0xf bank_mask:0xf
    v_add_f32_dpp v51, v47, v51 quad_perm:[3,3,3,3] row_mask:0xf bank_mask:0xf
    v_cvt_pk_bf16_f32 v48, v48, v49
    v_cvt_pk_bf16_f32 v50, v50, v51
    v_and_b32 v49, 0xffff0000, v48
    v_lshlrev_b32 v48, 16, v48
    v_and_b32 v51, 0xffff0000, v50
    v_lshlrev_b32 v50, 16, v50
    v_mul_f32 v48, s58, v48
    v_mul_f32 v49, s58, v49
    v_mul_f32 v50, s58, v50
    v_mul_f32 v51, s58, v51
    v_cvt_pk_bf16_f32 v48, v48, v49
    v_cvt_pk_bf16_f32 v49, v50, v51
    s_mov_b64 exec, s[60:61]
    ds_write_b64 v54, v[48:49] offset:0
    s_mov_b64 exec, -1
    s_waitcnt vmcnt(39)
    v_mfma_f32_16x16x32_bf16 v[32:35], v[112:115], v[8:11], 0
    v_mfma_f32_16x16x32_bf16 v[32:35], v[116:119], v[12:15], v[32:35]
    v_mfma_f32_16x16x32_bf16 v[32:35], v[120:123], v[16:19], v[32:35]
    s_waitcnt vmcnt(36)
    v_mfma_f32_16x16x32_bf16 v[36:39], v[124:127], v[8:11], 0
    v_mfma_f32_16x16x32_bf16 v[36:39], v[128:131], v[12:15], v[36:39]
    v_mfma_f32_16x16x32_bf16 v[36:39], v[132:135], v[16:19], v[36:39]
    s_waitcnt vmcnt(33)
    v_mfma_f32_16x16x32_bf16 v[40:43], v[136:139], v[8:11], 0
    v_mfma_f32_16x16x32_bf16 v[40:43], v[140:143], v[12:15], v[40:43]
    v_mfma_f32_16x16x32_bf16 v[40:43], v[144:147], v[16:19], v[40:43]
    s_waitcnt vmcnt(30)
    v_mfma_f32_16x16x32_bf16 v[44:47], v[148:151], v[8:11], 0
    v_mfma_f32_16x16x32_bf16 v[44:47], v[152:155], v[12:15], v[44:47]
    v_mfma_f32_16x16x32_bf16 v[44:47], v[156:159], v[16:19], v[44:47]
    v_mov_b32_dpp v48, v32 quad_perm:[0,0,0,0] row_mask:0xf bank_mask:0xf
    v_add_f32_dpp v48, v33, v48 quad_perm:[1,1,1,1] row_mask:0xf bank_mask:0xf
    v_add_f32_dpp v48, v34, v48 quad_perm:[2,2,2,2] row_mask:0xf bank_mask:0xf
    v_add_f32_dpp v48, v35, v48 quad_perm:[3,3,3,3] row_mask:0xf bank_mask:0xf
    v_mov_b32_dpp v49, v36 quad_perm:[0,0,0,0] row_mask:0xf bank_mask:0xf
    v_add_f32_dpp v49, v37, v49 quad_perm:[1,1,1,1] row_mask:0xf bank_mask:0xf
    v_add_f32_dpp v49, v38, v49 quad_perm:[2,2,2,2] row_mask:0xf bank_mask:0xf
    v_add_f32_dpp v49, v39, v49 quad_perm:[3,3,3,3] row_mask:0xf bank_mask:0xf
    v_mov_b32_dpp v50, v40 quad_perm:[0,0,0,0] row_mask:0xf bank_mask:0xf
    v_add_f32_dpp v50, v41, v50 quad_perm:[1,1,1,1] row_mask:0xf bank_mask:0xf
    v_add_f32_dpp v50, v42, v50 quad_perm:[2,2,2,2] row_mask:0xf bank_mask:0xf
    v_add_f32_dpp v50, v43, v50 quad_perm:[3,3,3,3] row_mask:0xf bank_mask:0xf
    v_mov_b32_dpp v51, v44 quad_perm:[0,0,0,0] row_mask:0xf bank_mask:0xf
    v_add_f32_dpp v51, v45, v51 quad_perm:[1,1,1,1] row_mask:0xf bank_mask:0xf
    v_add_f32_dpp v51, v46, v51 quad_perm:[2,2,2,2] row_mask:0xf bank_mask:0xf
    v_add_f32_dpp v51, v47, v51 quad_perm:[3,3,3,3] row_mask:0xf bank_mask:0xf
    v_cvt_pk_bf16_f32 v48, v48, v49
    v_cvt_pk_bf16_f32 v50, v50, v51
    v_and_b32 v49, 0xffff0000, v48
    v_lshlrev_b32 v48, 16, v48
    v_and_b32 v51, 0xffff0000, v50
    v_lshlrev_b32 v50, 16, v50
    v_mul_f32 v48, s58, v48
    v_mul_f32 v49, s58, v49
    v_mul_f32 v50, s58, v50
    v_mul_f32 v51, s58, v51
    v_cvt_pk_bf16_f32 v48, v48, v49
    v_cvt_pk_bf16_f32 v49, v50, v51
    s_mov_b64 exec, s[60:61]
    ds_write_b64 v54, v[48:49] offset:64
    s_mov_b64 exec, -1
    s_waitcnt vmcnt(27)
    v_mfma_f32_16x16x32_bf16 v[32:35], v[160:163], v[8:11], 0
    v_mfma_f32_16x16x32_bf16 v[32:35], v[164:167], v[12:15], v[32:35]
    v_mfma_f32_16x16x32_bf16 v[32:35], v[168:171], v[16:19], v[32:35]
    s_waitcnt vmcnt(24)
    v_mfma_f32_16x16x32_bf16 v[36:39], v[172:175], v[8:11], 0
    v_mfma_f32_16x16x32_bf16 v[36:39], v[176:179], v[12:15], v[36:39]
    v_mfma_f32_16x16x32_bf16 v[36:39], v[180:183], v[16:19], v[36:39]
    s_waitcnt vmcnt(21)
    v_mfma_f32_16x16x32_bf16 v[40:43], v[184:187], v[8:11], 0
    v_mfma_f32_16x16x32_bf16 v[40:43], v[188:191], v[12:15], v[40:43]
    v_mfma_f32_16x16x32_bf16 v[40:43], v[192:195], v[16:19], v[40:43]
    s_waitcnt vmcnt(18)
    v_mfma_f32_16x16x32_bf16 v[44:47], v[196:199], v[8:11], 0
    v_mfma_f32_16x16x32_bf16 v[44:47], v[200:203], v[12:15], v[44:47]
    v_mfma_f32_16x16x32_bf16 v[44:47], v[204:207], v[16:19], v[44:47]
    v_mov_b32_dpp v48, v32 quad_perm:[0,0,0,0] row_mask:0xf bank_mask:0xf
    v_add_f32_dpp v48, v33, v48 quad_perm:[1,1,1,1] row_mask:0xf bank_mask:0xf
    v_add_f32_dpp v48, v34, v48 quad_perm:[2,2,2,2] row_mask:0xf bank_mask:0xf
    v_add_f32_dpp v48, v35, v48 quad_perm:[3,3,3,3] row_mask:0xf bank_mask:0xf
    v_mov_b32_dpp v49, v36 quad_perm:[0,0,0,0] row_mask:0xf bank_mask:0xf
    v_add_f32_dpp v49, v37, v49 quad_perm:[1,1,1,1] row_mask:0xf bank_mask:0xf
    v_add_f32_dpp v49, v38, v49 quad_perm:[2,2,2,2] row_mask:0xf bank_mask:0xf
    v_add_f32_dpp v49, v39, v49 quad_perm:[3,3,3,3] row_mask:0xf bank_mask:0xf
    v_mov_b32_dpp v50, v40 quad_perm:[0,0,0,0] row_mask:0xf bank_mask:0xf
    v_add_f32_dpp v50, v41, v50 quad_perm:[1,1,1,1] row_mask:0xf bank_mask:0xf
    v_add_f32_dpp v50, v42, v50 quad_perm:[2,2,2,2] row_mask:0xf bank_mask:0xf
    v_add_f32_dpp v50, v43, v50 quad_perm:[3,3,3,3] row_mask:0xf bank_mask:0xf
    v_mov_b32_dpp v51, v44 quad_perm:[0,0,0,0] row_mask:0xf bank_mask:0xf
    v_add_f32_dpp v51, v45, v51 quad_perm:[1,1,1,1] row_mask:0xf bank_mask:0xf
    v_add_f32_dpp v51, v46, v51 quad_perm:[2,2,2,2] row_mask:0xf bank_mask:0xf
    v_add_f32_dpp v51, v47, v51 quad_perm:[3,3,3,3] row_mask:0xf bank_mask:0xf
    v_cvt_pk_bf16_f32 v48, v48, v49
    v_cvt_pk_bf16_f32 v50, v50, v51
    v_and_b32 v49, 0xffff0000, v48
    v_lshlrev_b32 v48, 16, v48
    v_and_b32 v51, 0xffff0000, v50
    v_lshlrev_b32 v50, 16, v50
    v_mul_f32 v48, s58, v48
    v_mul_f32 v49, s58, v49
    v_mul_f32 v50, s58, v50
    v_mul_f32 v51, s58, v51
    v_cvt_pk_bf16_f32 v48, v48, v49
    v_cvt_pk_bf16_f32 v49, v50, v51
    s_mov_b64 exec, s[60:61]
    ds_write_b64 v54, v[48:49] offset:128
    s_mov_b64 exec, -1
    s_waitcnt vmcnt(15)
    v_mfma_f32_16x16x32_bf16 v[32:35], v[208:211], v[8:11], 0
    v_mfma_f32_16x16x32_bf16 v[32:35], v[212:215], v[12:15], v[32:35]
    v_mfma_f32_16x16x32_bf16 v[32:35], v[216:219], v[16:19], v[32:35]
    s_waitcnt vmcnt(12)
    v_mfma_f32_16x16x32_bf16 v[36:39], v[220:223], v[8:11], 0
    v_mfma_f32_16x16x32_bf16 v[36:39], v[224:227], v[12:15], v[36:39]
    v_mfma_f32_16x16x32_bf16 v[36:39], v[228:231], v[16:19], v[36:39]
    s_waitcnt vmcnt(9)
    v_mfma_f32_16x16x32_bf16 v[40:43], v[232:235], v[8:11], 0
    v_mfma_f32_16x16x32_bf16 v[40:43], v[236:239], v[12:15], v[40:43]
    v_mfma_f32_16x16x32_bf16 v[40:43], v[240:243], v[16:19], v[40:43]
    s_waitcnt vmcnt(6)
    v_mfma_f32_16x16x32_bf16 v[44:47], v[244:247], v[8:11], 0
    v_mfma_f32_16x16x32_bf16 v[44:47], v[248:251], v[12:15], v[44:47]
    v_mfma_f32_16x16x32_bf16 v[44:47], v[252:255], v[16:19], v[44:47]
    v_mov_b32_dpp v48, v32 quad_perm:[0,0,0,0] row_mask:0xf bank_mask:0xf
    v_add_f32_dpp v48, v33, v48 quad_perm:[1,1,1,1] row_mask:0xf bank_mask:0xf
    v_add_f32_dpp v48, v34, v48 quad_perm:[2,2,2,2] row_mask:0xf bank_mask:0xf
    v_add_f32_dpp v48, v35, v48 quad_perm:[3,3,3,3] row_mask:0xf bank_mask:0xf
    v_mov_b32_dpp v49, v36 quad_perm:[0,0,0,0] row_mask:0xf bank_mask:0xf
    v_add_f32_dpp v49, v37, v49 quad_perm:[1,1,1,1] row_mask:0xf bank_mask:0xf
    v_add_f32_dpp v49, v38, v49 quad_perm:[2,2,2,2] row_mask:0xf bank_mask:0xf
    v_add_f32_dpp v49, v39, v49 quad_perm:[3,3,3,3] row_mask:0xf bank_mask:0xf
    v_mov_b32_dpp v50, v40 quad_perm:[0,0,0,0] row_mask:0xf bank_mask:0xf
    v_add_f32_dpp v50, v41, v50 quad_perm:[1,1,1,1] row_mask:0xf bank_mask:0xf
    v_add_f32_dpp v50, v42, v50 quad_perm:[2,2,2,2] row_mask:0xf bank_mask:0xf
    v_add_f32_dpp v50, v43, v50 quad_perm:[3,3,3,3] row_mask:0xf bank_mask:0xf
    v_mov_b32_dpp v51, v44 quad_perm:[0,0,0,0] row_mask:0xf bank_mask:0xf
    v_add_f32_dpp v51, v45, v51 quad_perm:[1,1,1,1] row_mask:0xf bank_mask:0xf
    v_add_f32_dpp v51, v46, v51 quad_perm:[2,2,2,2] row_mask:0xf bank_mask:0xf
    v_add_f32_dpp v51, v47, v51 quad_perm:[3,3,3,3] row_mask:0xf bank_mask:0xf
    v_cvt_pk_bf16_f32 v48, v48, v49
    v_cvt_pk_bf16_f32 v50, v50, v51
    v_and_b32 v49, 0xffff0000, v48
    v_lshlrev_b32 v48, 16, v48
    v_and_b32 v51, 0xffff0000, v50
    v_lshlrev_b32 v50, 16, v50
    v_mul_f32 v48, s58, v48
    v_mul_f32 v49, s58, v49
    v_mul_f32 v50, s58, v50
    v_mul_f32 v51, s58, v51
    v_cvt_pk_bf16_f32 v48, v48, v49
    v_cvt_pk_bf16_f32 v49, v50, v51
    s_mov_b64 exec, s[60:61]
    ds_write_b64 v54, v[48:49] offset:192
    s_mov_b64 exec, -1
    v_mov_b32 v113, 0
    v_writelane_b32 v113, s50, 0
    v_writelane_b32 v113, s51, 1
    v_writelane_b32 v113, s53, 2
    v_writelane_b32 v113, s54, 3
    v_writelane_b32 v113, s52, 4
    s_mov_b32 s50, s9
    s_mov_b32 s62, 4
    s_mov_b32 s65, 5
    s_mov_b32 s82, 0
    s_mov_b32 s83, 896
    s_mov_b32 s84, 64
    s_mov_b32 s72, 896
    s_mov_b32 s7, 0
    s_mov_b32 s74, 896
    s_sub_u32 s10, s6, 5
    s_cmp_lt_u32 s10, 2
    s_cselect_b32 s10, s4, 31
    s_mov_b32 s98, 1408
    s_mov_b32 s99, 1376
    s_cmp_lt_u32 s10, 24
    s_cselect_b32 s98, 1408, s98
    s_cselect_b32 s99, 1344, s99
    s_and_b32 s73, s4, 7
    s_lshl_b32 s73, s73, 9
    s_add_u32 s73, s73, 28672
    s_and_b32 s15, s4, 7
    s_mul_i32 s15, s15, 192
    s_sub_u32 s15, s15, 896
    s_mov_b32 s57, 0
    s_mov_b32 s66, 0
    v_mov_b32 v114, 0xff61b1e6
    v_mov_b32 v115, 0
    v_mov_b32 v112, v2
    v_lshrrev_b32 v50, 4, v1
    v_mul_u32_u24 v50, 12, v50
    v_and_b32 v51, 15, v1
    v_min_u32 v51, 11, v51
    v_add_u32 v50, v50, v51
    v_lshlrev_b32 v117, 3, v50
    v_lshrrev_b32 v116, 3, v50
    v_lshlrev_b32 v116, 8, v116
    v_and_b32 v50, 7, v50
    v_lshl_add_u32 v116, v50, 4, v116
    v_add_u32 v116, 46080, v116
    v_lshlrev_b32 v208, 3, v1
    v_mov_b32 v118, 0
    v_mov_b32 v119, 1
.p2align 6
L_kloop:
    s_lshr_b32 s10, s52, 12
    s_cmp_lg_u32 s10, s56
    s_cbranch_scc1 L_qs_k
L_qb_k:
    s_waitcnt vmcnt(5)
    s_waitcnt vmcnt(4)
    s_add_u32 s13, s50, 6144
    buffer_load_dwordx4 v[88:91], v2, s[40:43], s13 offen offset:0 nt
    s_waitcnt vmcnt(4)
    s_add_u32 s13, s50, 6144
    buffer_load_dwordx4 v[92:95], v2, s[40:43], s13 offen offset:256 nt
    s_add_u32 s13, s50, 6144
    buffer_load_dwordx4 v[96:99], v2, s[40:43], s13 offen offset:512 nt
    s_waitcnt lgkmcnt(0)
    s_add_u32 s54, s55, s72
L_dr_k:
    s_cmp_lg_u32 s82, 0
    s_cbranch_scc1 L_dv_k
    s_cmp_ge_u32 s54, s83
    s_cbranch_scc1 L_dv_k
    s_cmp_ge_u32 s65, s84
    s_cbranch_scc1 L_dv_k
    s_lshr_b32 s10, s54, 7
    s_lshl_b32 s10, s10, 12
    s_add_u32 s10, s10, s67
    s_and_b32 s53, s54, 96
    s_lshl_b32 s53, s53, 2
    s_add_u32 s53, s53, s75
    s_and_b32 s53, s53, 511
    s_add_u32 s53, s53, s10
    s_add_u32 s10, s54, s15
    s_and_b32 s10, s10, 511
    s_add_u32 s10, s10, s73
    s_cmp_ge_u32 s54, 896
    s_cselect_b32 s53, s10, s53
    s_cmp_ge_u32 s54, 896
    s_cselect_b32 s85, 3, 0
    s_mov_b32 m0, s65
    s_add_u32 s55, s55, 32
    s_cmp_lt_u32 s54, 896
    s_cbranch_scc1 L_dna_k
    s_sub_u32 s10, s54, 896
    s_cmp_lt_u32 s10, 0
    s_cbranch_scc1 L_dna_k
    s_mov_b32 s55, 512
    s_cmp_ge_u32 s54, s98
    s_cbranch_scc1 L_dna_k
    s_mov_b32 s55, 1
    s_atomic_add s55, s[48:49], 0 glc
L_dna_k:
    v_writelane_b32 v113, s53, m0
    s_mov_b32 s63, s65
    s_add_u32 s65, s65, 1
    s_mov_b64 s[76:77], s[18:19]
    v_mov_b32 v112, v2
    s_branch L_dd_k
L_dv_k:
    s_cmp_ge_u32 s54, s74
    s_cbranch_scc1 L_de_k
L_dnf_k:
    s_cmp_ge_u32 s82, s65
    s_cbranch_scc1 L_dx_k
    s_mov_b32 m0, s82
    s_mov_b32 s63, s82
    v_readlane_b32 s53, v113, m0
    s_add_u32 s82, s82, 1
    s_mov_b64 s[76:77], s[20:21]
    v_mov_b32 v112, v3
    s_mov_b32 s85, 1
    s_cmp_lg_u32 s82, s65
    s_cbranch_scc1 L_dd_k
    s_cmp_lg_u32 s7, 1
    s_cbranch_scc1 L_dd_k
    s_mov_b32 s55, 1
    s_atomic_add s55, s[48:49], 0 glc
L_dd_k:
    s_mul_i32 s51, s53, 12288
L_dd_k_e:
    v_mfma_f32_16x16x32_bf16 v[32:35], v[64:67], v[8:11], 0
    v_mfma_f32_16x16x32_bf16 v[32:35], v[68:71], v[12:15], v[32:35]
    v_mfma_f32_16x16x32_bf16 v[32:35], v[72:75], v[16:19], v[32:35]
    s_waitcnt vmcnt(5)
    s_waitcnt vmcnt(4)
    s_add_u32 s13, s50, 9216
    buffer_load_dwordx4 v[100:103], v2, s[40:43], s13 offen offset:0 nt
    s_waitcnt vmcnt(4)
    s_add_u32 s13, s50, 9216
    buffer_load_dwordx4 v[104:107], v2, s[40:43], s13 offen offset:256 nt
    v_mfma_f32_16x16x32_bf16 v[36:39], v[76:79], v[8:11], 0
    v_mfma_f32_16x16x32_bf16 v[36:39], v[80:83], v[12:15], v[36:39]
    v_mfma_f32_16x16x32_bf16 v[36:39], v[84:87], v[16:19], v[36:39]
    s_waitcnt vmcnt(4)
    s_add_u32 s13, s50, 9216
    buffer_load_dwordx4 v[108:111], v2, s[40:43], s13 offen offset:512 nt
    s_waitcnt vmcnt(4)
    buffer_load_dwordx4 v[64:67], v112, s[76:79], s51 offen offset:0 nt
    s_waitcnt vmcnt(4)
    buffer_load_dwordx4 v[68:71], v112, s[76:79], s51 offen offset:256 nt
    v_mfma_f32_16x16x32_bf16 v[40:43], v[88:91], v[8:11], 0
    v_mfma_f32_16x16x32_bf16 v[40:43], v[92:95], v[12:15], v[40:43]
    v_mfma_f32_16x16x32_bf16 v[40:43], v[96:99], v[16:19], v[40:43]
    s_waitcnt vmcnt(4)
    buffer_load_dwordx4 v[72:75], v112, s[76:79], s51 offen offset:512 nt
    s_waitcnt vmcnt(4)
    s_add_u32 s13, s51, 3072
    buffer_load_dwordx4 v[76:79], v112, s[76:79], s13 offen offset:0 nt
    s_waitcnt vmcnt(4)
    s_add_u32 s13, s51, 3072
    buffer_load_dwordx4 v[80:83], v112, s[76:79], s13 offen offset:256 nt
    s_add_u32 s13, s51, 3072
    buffer_load_dwordx4 v[84:87], v112, s[76:79], s13 offen offset:512 nt
    v_mfma_f32_16x16x32_bf16 v[44:47], v[100:103], v[8:11], 0
    v_mfma_f32_16x16x32_bf16 v[44:47], v[104:107], v[12:15], v[44:47]
    v_mfma_f32_16x16x32_bf16 v[44:47], v[108:111], v[16:19], v[44:47]
    v_mov_b32_dpp v48, v32 quad_perm:[0,0,0,0] row_mask:0xf bank_mask:0xf
    v_add_f32_dpp v48, v33, v48 quad_perm:[1,1,1,1] row_mask:0xf bank_mask:0xf
    v_add_f32_dpp v48, v34, v48 quad_perm:[2,2,2,2] row_mask:0xf bank_mask:0xf
    v_add_f32_dpp v48, v35, v48 quad_perm:[3,3,3,3] row_mask:0xf bank_mask:0xf
    v_mov_b32_dpp v49, v36 quad_perm:[0,0,0,0] row_mask:0xf bank_mask:0xf
    v_add_f32_dpp v49, v37, v49 quad_perm:[1,1,1,1] row_mask:0xf bank_mask:0xf
    v_add_f32_dpp v49, v38, v49 quad_perm:[2,2,2,2] row_mask:0xf bank_mask:0xf
    v_add_f32_dpp v49, v39, v49 quad_perm:[3,3,3,3] row_mask:0xf bank_mask:0xf
    v_mov_b32_dpp v50, v40 quad_perm:[0,0,0,0] row_mask:0xf bank_mask:0xf
    v_add_f32_dpp v50, v41, v50 quad_perm:[1,1,1,1] row_mask:0xf bank_mask:0xf
    v_add_f32_dpp v50, v42, v50 quad_perm:[2,2,2,2] row_mask:0xf bank_mask:0xf
    v_add_f32_dpp v50, v43, v50 quad_perm:[3,3,3,3] row_mask:0xf bank_mask:0xf
    v_mov_b32_dpp v51, v44 quad_perm:[0,0,0,0] row_mask:0xf bank_mask:0xf
    v_add_f32_dpp v51, v45, v51 quad_perm:[1,1,1,1] row_mask:0xf bank_mask:0xf
    v_add_f32_dpp v51, v46, v51 quad_perm:[2,2,2,2] row_mask:0xf bank_mask:0xf
    v_add_f32_dpp v51, v47, v51 quad_perm:[3,3,3,3] row_mask:0xf bank_mask:0xf
    v_cvt_pk_bf16_f32 v48, v48, v49
    v_cvt_pk_bf16_f32 v50, v50, v51
    v_and_b32 v49, 0xffff0000, v48
    v_lshlrev_b32 v48, 16, v48
    v_and_b32 v51, 0xffff0000, v50
    v_lshlrev_b32 v50, 16, v50
    v_mul_f32 v48, s58, v48
    v_mul_f32 v49, s58, v49
    v_mul_f32 v50, s58, v50
    v_mul_f32 v51, s58, v51
    v_cvt_pk_bf16_f32 v48, v48, v49
    v_cvt_pk_bf16_f32 v49, v50, v51
    s_lshl_b32 s10, s62, 6
    v_add_u32 v50, s10, v54
    s_mov_b64 exec, s[60:61]
    ds_write_b64 v50, v[48:49]
    s_mov_b64 exec, -1
    s_mov_b32 s50, s51
    s_mov_b32 s52, s53
    s_mov_b32 s62, s63
    s_cmp_eq_u32 s85, 0
    s_cbranch_scc1 L_kloop
.p2align 6
L_vloop:
    s_lshr_b32 s10, s52, 12
    s_cmp_lg_u32 s10, s57
    s_cbranch_scc1 L_vlim
L_vlimback:
    s_lshl_b32 s10, s62, 6
    v_add_u32 v48, s10, v54
    ds_read_b64 v[44:45], v48
    s_waitcnt vmcnt(5)
    s_waitcnt vmcnt(4)
    s_add_u32 s13, s50, 6144
    buffer_load_dwordx4 v[88:91], v3, s[44:47], s13 offen offset:0 nt
    s_waitcnt vmcnt(4)
    s_add_u32 s13, s50, 6144
    buffer_load_dwordx4 v[92:95], v3, s[44:47], s13 offen offset:256 nt
    s_add_u32 s13, s50, 6144
    buffer_load_dwordx4 v[96:99], v3, s[44:47], s13 offen offset:512 nt
    s_waitcnt lgkmcnt(0)
    s_add_u32 s54, s55, s72
L_dr_v:
    s_cmp_lg_u32 s82, 0
    s_cbranch_scc1 L_dv_v
    s_cmp_ge_u32 s54, s83
    s_cbranch_scc1 L_dv_v
    s_cmp_ge_u32 s65, s84
    s_cbranch_scc1 L_dv_v
    s_lshr_b32 s10, s54, 7
    s_lshl_b32 s10, s10, 12
    s_add_u32 s10, s10, s67
    s_and_b32 s53, s54, 96
    s_lshl_b32 s53, s53, 2
    s_add_u32 s53, s53, s75
    s_and_b32 s53, s53, 511
    s_add_u32 s53, s53, s10
    s_add_u32 s10, s54, s15
    s_and_b32 s10, s10, 511
    s_add_u32 s10, s10, s73
    s_cmp_ge_u32 s54, 896
    s_cselect_b32 s53, s10, s53
    s_cmp_ge_u32 s54, 896
    s_cselect_b32 s85, 3, 0
    s_mov_b32 m0, s65
    s_add_u32 s55, s55, 32
    s_cmp_lt_u32 s54, 896
    s_cbranch_scc1 L_dna_v
    s_sub_u32 s10, s54, 896
    s_cmp_lt_u32 s10, 0
    s_cbranch_scc1 L_dna_v
    s_mov_b32 s55, 512
    s_cmp_ge_u32 s54, s98
    s_cbranch_scc1 L_dna_v
    s_mov_b32 s55, 1
    s_atomic_add s55, s[48:49], 0 glc
L_dna_v:
    v_writelane_b32 v113, s53, m0
    s_mov_b32 s63, s65
    s_add_u32 s65, s65, 1
    s_mov_b64 s[76:77], s[18:19]
    v_mov_b32 v112, v2
    s_branch L_dd_v
L_dv_v:
    s_cmp_ge_u32 s54, s74
    s_cbranch_scc1 L_de_v
L_dnf_v:
    s_cmp_ge_u32 s82, s65
    s_cbranch_scc1 L_dx_v
    s_mov_b32 m0, s82
    s_mov_b32 s63, s82
    v_readlane_b32 s53, v113, m0
    s_add_u32 s82, s82, 1
    s_mov_b64 s[76:77], s[20:21]
    v_mov_b32 v112, v3
    s_mov_b32 s85, 1
    s_cmp_lg_u32 s82, s65
    s_cbranch_scc1 L_dd_v
    s_cmp_lg_u32 s7, 1
    s_cbranch_scc1 L_dd_v
    s_mov_b32 s55, 1
    s_atomic_add s55, s[48:49], 0 glc
L_dd_v:
    s_mul_i32 s51, s53, 12288
L_dd_v_e:
    v_lshlrev_b32 v40, 16, v44
    v_and_b32 v41, 0xffff0000, v44
    v_lshlrev_b32 v42, 16, v45
    v_and_b32 v43, 0xffff0000, v45
    v_max3_f32 v48, v40, v41, v42
    v_max_f32 v48, v48, v43
    v_cmp_gt_f32 vcc, v48, v114
    s_cbranch_vccnz L_rare
L_back:
    v_sub_f32 v40, v40, v114
    v_sub_f32 v41, v41, v114
    v_sub_f32 v42, v42, v114
    v_sub_f32 v43, v43, v114
    v_mul_f32 v40, s59, v40
    v_mul_f32 v41, s59, v41
    v_mul_f32 v42, s59, v42
    v_mul_f32 v43, s59, v43
    v_exp_f32 v40, v40
    v_exp_f32 v41, v41
    v_exp_f32 v42, v42
    v_exp_f32 v43, v43
    s_nop 0
    v_add_f32 v48, v40, v41
    v_add_f32 v49, v42, v43
    v_cvt_pk_bf16_f32 v40, v40, v40
    v_cvt_pk_bf16_f32 v41, v41, v41
    v_cvt_pk_bf16_f32 v42, v42, v42
    v_cvt_pk_bf16_f32 v43, v43, v43
    v_add_f32 v115, v115, v48
    v_add_f32 v115, v115, v49
    v_and_b32 v32, v40, v4
    v_and_b32 v33, v40, v5
    v_and_b32 v34, v40, v6
    v_and_b32 v35, v40, v7
    s_nop 1
    v_mfma_f32_16x16x32_bf16 v[20:23], v[64:67], v[32:35], v[20:23]
    v_mfma_f32_16x16x32_bf16 v[24:27], v[68:71], v[32:35], v[24:27]
    v_mfma_f32_16x16x32_bf16 v[28:31], v[72:75], v[32:35], v[28:31]
    s_waitcnt vmcnt(5)
    s_waitcnt vmcnt(4)
    s_add_u32 s13, s50, 9216
    buffer_load_dwordx4 v[100:103], v3, s[44:47], s13 offen offset:0 nt
    s_waitcnt vmcnt(4)
    s_add_u32 s13, s50, 9216
    buffer_load_dwordx4 v[104:107], v3, s[44:47], s13 offen offset:256 nt
    v_and_b32 v36, v41, v4
    v_and_b32 v37, v41, v5
    v_and_b32 v38, v41, v6
    v_and_b32 v39, v41, v7
    s_nop 1
    v_mfma_f32_16x16x32_bf16 v[20:23], v[76:79], v[36:39], v[20:23]
    v_mfma_f32_16x16x32_bf16 v[24:27], v[80:83], v[36:39], v[24:27]
    v_mfma_f32_16x16x32_bf16 v[28:31], v[84:87], v[36:39], v[28:31]
    s_waitcnt vmcnt(4)
    s_add_u32 s13, s50, 9216
    buffer_load_dwordx4 v[108:111], v3, s[44:47], s13 offen offset:512 nt
    s_waitcnt vmcnt(4)
    buffer_load_dwordx4 v[64:67], v112, s[76:79], s51 offen offset:0 nt
    s_waitcnt vmcnt(4)
    buffer_load_dwordx4 v[68:71], v112, s[76:79], s51 offen offset:256 nt
    v_and_b32 v32, v42, v4
    v_and_b32 v33, v42, v5
    v_and_b32 v34, v42, v6
    v_and_b32 v35, v42, v7
    s_nop 1
    v_mfma_f32_16x16x32_bf16 v[20:23], v[88:91], v[32:35], v[20:23]
    v_mfma_f32_16x16x32_bf16 v[24:27], v[92:95], v[32:35], v[24:27]
    v_mfma_f32_16x16x32_bf16 v[28:31], v[96:99], v[32:35], v[28:31]
    s_waitcnt vmcnt(4)
    buffer_load_dwordx4 v[72:75], v112, s[76:79], s51 offen offset:512 nt
    s_waitcnt vmcnt(4)
    s_add_u32 s13, s51, 3072
    buffer_load_dwordx4 v[76:79], v112, s[76:79], s13 offen offset:0 nt
    s_waitcnt vmcnt(4)
    s_add_u32 s13, s51, 3072
    buffer_load_dwordx4 v[80:83], v112, s[76:79], s13 offen offset:256 nt
    s_add_u32 s13, s51, 3072
    buffer_load_dwordx4 v[84:87], v112, s[76:79], s13 offen offset:512 nt
    v_and_b32 v36, v43, v4
    v_and_b32 v37, v43, v5
    v_and_b32 v38, v43, v6
    v_and_b32 v39, v43, v7
    s_nop 1
    v_mfma_f32_16x16x32_bf16 v[20:23], v[100:103], v[36:39], v[20:23]
    v_mfma_f32_16x16x32_bf16 v[24:27], v[104:107], v[36:39], v[24:27]
    v_mfma_f32_16x16x32_bf16 v[28:31], v[108:111], v[36:39], v[28:31]
    s_mov_b32 s50, s51
    s_mov_b32 s52, s53
    s_mov_b32 s62, s63
    s_cmp_eq_u32 s85, 0
    s_cbranch_scc1 L_kloop
    s_cmp_lg_u32 s85, 3
    s_cbranch_scc1 L_vloop
    s_add_u32 s13, s50, 6144
    buffer_load_dwordx4 v[88:91], v2, s[40:43], s13 offen offset:0 nt
    s_add_u32 s13, s50, 6144
    buffer_load_dwordx4 v[92:95], v2, s[40:43], s13 offen offset:256 nt
    s_add_u32 s13, s50, 6144
    buffer_load_dwordx4 v[96:99], v2, s[40:43], s13 offen offset:512 nt
    s_add_u32 s13, s50, 9216
    buffer_load_dwordx4 v[100:103], v2, s[40:43], s13 offen offset:0 nt
    s_add_u32 s13, s50, 9216
    buffer_load_dwordx4 v[104:107], v2, s[40:43], s13 offen offset:256 nt
    s_add_u32 s13, s50, 9216
    buffer_load_dwordx4 v[108:111], v2, s[40:43], s13 offen offset:512 nt
    buffer_load_dwordx4 v[160:163], v3, s[44:47], s50 offen offset:0 nt
    buffer_load_dwordx4 v[164:167], v3, s[44:47], s50 offen offset:256 nt
    buffer_load_dwordx4 v[168:171], v3, s[44:47], s50 offen offset:512 nt
    s_add_u32 s13, s50, 3072
    buffer_load_dwordx4 v[172:175], v3, s[44:47], s13 offen offset:0 nt
    buffer_load_dwordx4 v[176:179], v3, s[44:47], s13 offen offset:256 nt
    buffer_load_dwordx4 v[180:183], v3, s[44:47], s13 offen offset:512 nt
    s_add_u32 s13, s50, 6144
    buffer_load_dwordx4 v[184:187], v3, s[44:47], s13 offen offset:0 nt
    buffer_load_dwordx4 v[188:191], v3, s[44:47], s13 offen offset:256 nt
    buffer_load_dwordx4 v[192:195], v3, s[44:47], s13 offen offset:512 nt
    s_add_u32 s13, s50, 9216
    buffer_load_dwordx4 v[196:199], v3, s[44:47], s13 offen offset:0 nt
    buffer_load_dwordx4 v[200:203], v3, s[44:47], s13 offen offset:256 nt
    buffer_load_dwordx4 v[204:207], v3, s[44:47], s13 offen offset:512 nt
    s_mov_b32 s10, 7
    s_branch L_vlim
L_pent:
    s_mov_b32 s10, 7
L_qs_p:
    s_lshl_b32 s11, s10, 2
    v_mov_b32 v48, s11
    s_mov_b32 s14, 2097152
L_ql_p:
    ds_read_b32 v49, v48 offset:96
    s_waitcnt lgkmcnt(0)
    v_cmp_ne_u32 vcc, 0, v49
    s_cbranch_vccnz L_qok_p
    s_sleep 1
    s_sub_u32 s14, s14, 1
    s_cbranch_scc0 L_ql_p
L_qok_p:
    s_mov_b32 s56, s10
    s_mul_i32 s11, s10, 384
    v_mad_u32_u24 v48, v59, s11, v56
    v_mad_u32_u24 v49, v60, s11, v57
    v_mad_u32_u24 v50, v61, s11, v58
    ds_read_b128 v[8:11], v48
    ds_read_b128 v[12:15], v49
    ds_read_b128 v[16:19], v50
.p2align 6
L_ploop:
    s_waitcnt lgkmcnt(0)
    s_add_u32 s54, s55, 896
    s_cmp_lt_u32 s54, s99
    s_cbranch_scc1 L_pnf
    ds_write_b32 v118, v119 offset:16
L_pnf:
    s_add_u32 s53, s54, s15
    s_and_b32 s53, s53, 511
    s_add_u32 s53, s53, s73
    s_cmp_lt_u32 s54, 1408
    s_cselect_b32 s53, s53, 0
    s_cselect_b32 s42, 402653184, 0
    s_cselect_b32 s46, 402653184, 0
    s_mul_i32 s51, s53, 12288
    s_waitcnt vmcnt(21)
    v_mfma_f32_16x16x32_bf16 v[32:35], v[64:67], v[8:11], 0
    v_mfma_f32_16x16x32_bf16 v[32:35], v[68:71], v[12:15], v[32:35]
    v_mfma_f32_16x16x32_bf16 v[32:35], v[72:75], v[16:19], v[32:35]
    buffer_load_dwordx4 v[64:67], v2, s[40:43], s51 offen offset:0 nt
    buffer_load_dwordx4 v[68:71], v2, s[40:43], s51 offen offset:256 nt
    buffer_load_dwordx4 v[72:75], v2, s[40:43], s51 offen offset:512 nt
    s_waitcnt vmcnt(21)
    v_mfma_f32_16x16x32_bf16 v[36:39], v[76:79], v[8:11], 0
    v_mfma_f32_16x16x32_bf16 v[36:39], v[80:83], v[12:15], v[36:39]
    v_mfma_f32_16x16x32_bf16 v[36:39], v[84:87], v[16:19], v[36:39]
    s_add_u32 s13, s51, 3072
    buffer_load_dwordx4 v[76:79], v2, s[40:43], s13 offen offset:0 nt
    buffer_load_dwordx4 v[80:83], v2, s[40:43], s13 offen offset:256 nt
    buffer_load_dwordx4 v[84:87], v2, s[40:43], s13 offen offset:512 nt
    s_waitcnt vmcnt(21)
    v_mfma_f32_16x16x32_bf16 v[40:43], v[88:91], v[8:11], 0
    v_mfma_f32_16x16x32_bf16 v[40:43], v[92:95], v[12:15], v[40:43]
    v_mfma_f32_16x16x32_bf16 v[40:43], v[96:99], v[16:19], v[40:43]
    s_add_u32 s13, s51, 6144
    buffer_load_dwordx4 v[88:91], v2, s[40:43], s13 offen offset:0 nt
    buffer_load_dwordx4 v[92:95], v2, s[40:43], s13 offen offset:256 nt
    buffer_load_dwordx4 v[96:99], v2, s[40:43], s13 offen offset:512 nt
    s_waitcnt vmcnt(21)
    v_mfma_f32_16x16x32_bf16 v[44:47], v[100:103], v[8:11], 0
    v_mfma_f32_16x16x32_bf16 v[44:47], v[104:107], v[12:15], v[44:47]
    v_mfma_f32_16x16x32_bf16 v[44:47], v[108:111], v[16:19], v[44:47]
    s_add_u32 s13, s51, 9216
    buffer_load_dwordx4 v[100:103], v2, s[40:43], s13 offen offset:0 nt
    buffer_load_dwordx4 v[104:107], v2, s[40:43], s13 offen offset:256 nt
    buffer_load_dwordx4 v[108:111], v2, s[40:43], s13 offen offset:512 nt
    s_mov_b32 s55, 512
    s_cmp_ge_u32 s54, s98
    s_cbranch_scc1 L_pna
    s_mov_b32 s55, 1
    s_atomic_add s55, s[48:49], 0 glc
L_pna:
    v_mov_b32_dpp v48, v32 quad_perm:[0,0,0,0] row_mask:0xf bank_mask:0xf
    v_add_f32_dpp v48, v33, v48 quad_perm:[1,1,1,1] row_mask:0xf bank_mask:0xf
    v_add_f32_dpp v48, v34, v48 quad_perm:[2,2,2,2] row_mask:0xf bank_mask:0xf
    v_add_f32_dpp v48, v35, v48 quad_perm:[3,3,3,3] row_mask:0xf bank_mask:0xf
    v_mov_b32_dpp v49, v36 quad_perm:[0,0,0,0] row_mask:0xf bank_mask:0xf
    v_add_f32_dpp v49, v37, v49 quad_perm:[1,1,1,1] row_mask:0xf bank_mask:0xf
    v_add_f32_dpp v49, v38, v49 quad_perm:[2,2,2,2] row_mask:0xf bank_mask:0xf
    v_add_f32_dpp v49, v39, v49 quad_perm:[3,3,3,3] row_mask:0xf bank_mask:0xf
    v_mov_b32_dpp v50, v40 quad_perm:[0,0,0,0] row_mask:0xf bank_mask:0xf
    v_add_f32_dpp v50, v41, v50 quad_perm:[1,1,1,1] row_mask:0xf bank_mask:0xf
    v_add_f32_dpp v50, v42, v50 quad_perm:[2,2,2,2] row_mask:0xf bank_mask:0xf
    v_add_f32_dpp v50, v43, v50 quad_perm:[3,3,3,3] row_mask:0xf bank_mask:0xf
    v_mov_b32_dpp v51, v44 quad_perm:[0,0,0,0] row_mask:0xf bank_mask:0xf
    v_add_f32_dpp v51, v45, v51 quad_perm:[1,1,1,1] row_mask:0xf bank_mask:0xf
    v_add_f32_dpp v51, v46, v51 quad_perm:[2,2,2,2] row_mask:0xf bank_mask:0xf
    v_add_f32_dpp v51, v47, v51 quad_perm:[3,3,3,3] row_mask:0xf bank_mask:0xf
    v_cvt_pk_bf16_f32 v48, v48, v49
    v_cvt_pk_bf16_f32 v50, v50, v51
    v_and_b32 v49, 0xffff0000, v48
    v_lshlrev_b32 v48, 16, v48
    v_and_b32 v51, 0xffff0000, v50
    v_lshlrev_b32 v50, 16, v50
    v_mul_f32 v48, s58, v48
    v_mul_f32 v49, s58, v49
    v_mul_f32 v50, s58, v50
    v_mul_f32 v51, s58, v51
    v_cvt_pk_bf16_f32 v48, v48, v49
    v_cvt_pk_bf16_f32 v49, v50, v51
    v_lshlrev_b32 v40, 16, v48
    v_and_b32 v41, 0xffff0000, v48
    v_lshlrev_b32 v42, 16, v49
    v_and_b32 v43, 0xffff0000, v49
    v_max3_f32 v48, v40, v41, v42
    v_max_f32 v48, v48, v43
    v_cmp_gt_f32 vcc, v48, v114
    s_cbranch_vccnz L_rare_p
L_back_p:
    v_sub_f32 v40, v40, v114
    v_sub_f32 v41, v41, v114
    v_sub_f32 v42, v42, v114
    v_sub_f32 v43, v43, v114
    v_mul_f32 v40, s59, v40
    v_mul_f32 v41, s59, v41
    v_mul_f32 v42, s59, v42
    v_mul_f32 v43, s59, v43
    v_exp_f32 v40, v40
    v_exp_f32 v41, v41
    v_exp_f32 v42, v42
    v_exp_f32 v43, v43
    s_nop 0
    v_add_f32 v48, v40, v41
    v_add_f32 v49, v42, v43
    v_cvt_pk_bf16_f32 v40, v40, v40
    v_cvt_pk_bf16_f32 v41, v41, v41
    v_cvt_pk_bf16_f32 v42, v42, v42
    v_cvt_pk_bf16_f32 v43, v43, v43
    v_add_f32 v115, v115, v48
    v_add_f32 v115, v115, v49
    v_and_b32 v32, v40, v4
    v_and_b32 v33, v40, v5
    v_and_b32 v34, v40, v6
    v_and_b32 v35, v40, v7
    s_waitcnt vmcnt(21)
    s_nop 0
    v_mfma_f32_16x16x32_bf16 v[20:23], v[160:163], v[32:35], v[20:23]
    v_mfma_f32_16x16x32_bf16 v[24:27], v[164:167], v[32:35], v[24:27]
    v_mfma_f32_16x16x32_bf16 v[28:31], v[168:171], v[32:35], v[28:31]
    buffer_load_dwordx4 v[160:163], v3, s[44:47], s51 offen offset:0 nt
    buffer_load_dwordx4 v[164:167], v3, s[44:47], s51 offen offset:256 nt
    buffer_load_dwordx4 v[168:171], v3, s[44:47], s51 offen offset:512 nt
    v_and_b32 v36, v41, v4
    v_and_b32 v37, v41, v5
    v_and_b32 v38, v41, v6
    v_and_b32 v39, v41, v7
    s_waitcnt vmcnt(21)
    s_nop 0
    v_mfma_f32_16x16x32_bf16 v[20:23], v[172:175], v[36:39], v[20:23]
    v_mfma_f32_16x16x32_bf16 v[24:27], v[176:179], v[36:39], v[24:27]
    v_mfma_f32_16x16x32_bf16 v[28:31], v[180:183], v[36:39], v[28:31]
    s_add_u32 s13, s51, 3072
    buffer_load_dwordx4 v[172:175], v3, s[44:47], s13 offen offset:0 nt
    buffer_load_dwordx4 v[176:179], v3, s[44:47], s13 offen offset:256 nt
    buffer_load_dwordx4 v[180:183], v3, s[44:47], s13 offen offset:512 nt
    v_and_b32 v32, v42, v4
    v_and_b32 v33, v42, v5
    v_and_b32 v34, v42, v6
    v_and_b32 v35, v42, v7
    s_waitcnt vmcnt(21)
    s_nop 0
    v_mfma_f32_16x16x32_bf16 v[20:23], v[184:187], v[32:35], v[20:23]
    v_mfma_f32_16x16x32_bf16 v[24:27], v[188:191], v[32:35], v[24:27]
    v_mfma_f32_16x16x32_bf16 v[28:31], v[192:195], v[32:35], v[28:31]
    s_add_u32 s13, s51, 6144
    buffer_load_dwordx4 v[184:187], v3, s[44:47], s13 offen offset:0 nt
    buffer_load_dwordx4 v[188:191], v3, s[44:47], s13 offen offset:256 nt
    buffer_load_dwordx4 v[192:195], v3, s[44:47], s13 offen offset:512 nt
    v_and_b32 v36, v43, v4
    v_and_b32 v37, v43, v5
    v_and_b32 v38, v43, v6
    v_and_b32 v39, v43, v7
    s_waitcnt vmcnt(21)
    s_nop 0
    v_mfma_f32_16x16x32_bf16 v[20:23], v[196:199], v[36:39], v[20:23]
    v_mfma_f32_16x16x32_bf16 v[24:27], v[200:203], v[36:39], v[24:27]
    v_mfma_f32_16x16x32_bf16 v[28:31], v[204:207], v[36:39], v[28:31]
    s_add_u32 s13, s51, 9216
    buffer_load_dwordx4 v[196:199], v3, s[44:47], s13 offen offset:0 nt
    buffer_load_dwordx4 v[200:203], v3, s[44:47], s13 offen offset:256 nt
    buffer_load_dwordx4 v[204:207], v3, s[44:47], s13 offen offset:512 nt
    s_cmp_lt_u32 s54, 1408
    s_cbranch_scc1 L_ploop
    s_mov_b32 s10, 8
    s_branch L_vlim
L_rare:
    s_nop 1
    v_max_f32_dpp v49, v48, v48 row_ror:8 row_mask:0xf bank_mask:0xf
    v_mov_b32 v50, v49
    s_nop 1
    v_permlane16_swap_b32 v49, v50
    s_nop 1
    v_max_f32 v49, v49, v50
    v_mov_b32 v50, v49
    s_nop 1
    v_permlane32_swap_b32 v49, v50
    s_nop 1
    v_max_f32 v49, v49, v50
    v_sub_f32 v50, v114, v49
    v_mul_f32 v50, s59, v50
    v_exp_f32 v50, v50
    v_mov_b32 v114, v49
    s_nop 0
    v_mul_f32 v20, v20, v50
    v_mul_f32 v21, v21, v50
    v_mul_f32 v22, v22, v50
    v_mul_f32 v23, v23, v50
    v_mul_f32 v24, v24, v50
    v_mul_f32 v25, v25, v50
    v_mul_f32 v26, v26, v50
    v_mul_f32 v27, v27, v50
    v_mul_f32 v28, v28, v50
    v_mul_f32 v29, v29, v50
    v_mul_f32 v30, v30, v50
    v_mul_f32 v31, v31, v50
    v_mul_f32 v115, v115, v50
    s_branch L_back
L_rare_p:
    s_nop 1
    v_max_f32_dpp v49, v48, v48 row_ror:8 row_mask:0xf bank_mask:0xf
    v_mov_b32 v50, v49
    s_nop 1
    v_permlane16_swap_b32 v49, v50
    s_nop 1
    v_max_f32 v49, v49, v50
    v_mov_b32 v50, v49
    s_nop 1
    v_permlane32_swap_b32 v49, v50
    s_nop 1
    v_max_f32 v49, v49, v50
    v_sub_f32 v50, v114, v49
    v_mul_f32 v50, s59, v50
    v_exp_f32 v50, v50
    v_mov_b32 v114, v49
    s_nop 0
    v_mul_f32 v20, v20, v50
    v_mul_f32 v21, v21, v50
    v_mul_f32 v22, v22, v50
    v_mul_f32 v23, v23, v50
    v_mul_f32 v24, v24, v50
    v_mul_f32 v25, v25, v50
    v_mul_f32 v26, v26, v50
    v_mul_f32 v27, v27, v50
    v_mul_f32 v28, v28, v50
    v_mul_f32 v29, v29, v50
    v_mul_f32 v30, v30, v50
    v_mul_f32 v31, v31, v50
    v_mul_f32 v115, v115, v50
    s_branch L_back_p
L_qs_k:
    s_lshl_b32 s11, s10, 2
    v_mov_b32 v48, s11
    s_mov_b32 s14, 2097152
L_ql_k:
    ds_read_b32 v49, v48 offset:96
    s_waitcnt lgkmcnt(0)
    v_cmp_ne_u32 vcc, 0, v49
    s_cbranch_vccnz L_qok_k
    s_sleep 1
    s_sub_u32 s14, s14, 1
    s_cbranch_scc0 L_ql_k
L_qok_k:
    s_mov_b32 s56, s10
    s_mul_i32 s11, s10, 384
    v_mad_u32_u24 v48, v59, s11, v56
    v_mad_u32_u24 v49, v60, s11, v57
    v_mad_u32_u24 v50, v61, s11, v58
    ds_read_b128 v[8:11], v48
    ds_read_b128 v[12:15], v49
    ds_read_b128 v[16:19], v50
    s_branch L_qb_k
L_de_k:
    s_cmp_eq_u32 s7, 1
    s_cbranch_scc1 L_df_k
    s_mov_b32 s10, 7
L_qs_e_k:
    s_lshl_b32 s11, s10, 2
    v_mov_b32 v48, s11
    s_mov_b32 s14, 2097152
L_ql_e_k:
    ds_read_b32 v49, v48 offset:96
    s_waitcnt lgkmcnt(0)
    v_cmp_ne_u32 vcc, 0, v49
    s_cbranch_vccnz L_qok_e_k
    s_sleep 1
    s_sub_u32 s14, s14, 1
    s_cbranch_scc0 L_ql_e_k
L_qok_e_k:
    s_and_b32 s10, s4, 7
    s_lshl_b32 s10, s10, 8
    s_add_u32 s10, s10, 16384
    s_add_u32 s48, s38, s10
    s_addc_u32 s49, s39, 0
    s_mov_b32 s72, 896
    s_mov_b32 s7, 1
    s_mov_b32 s74, s99
    s_mov_b32 s55, 0
    s_cmp_lt_u32 s82, s65
    s_cbranch_scc1 L_dnf_k
    s_mov_b32 s55, 1
    s_atomic_add s55, s[48:49], 0 glc
    s_branch L_dnf_k
L_df_k:
    ds_write_b32 v118, v119 offset:16
    s_branch L_dnf_k
L_dx_k:
    s_mov_b32 s65, 0
    s_mov_b32 s82, 0
    s_waitcnt lgkmcnt(0)
    s_add_u32 s54, s55, s72
    s_cmp_eq_u32 s7, 1
    s_cselect_b32 s83, 1408, s83
    s_cselect_b32 s84, 1, s84
    s_cmp_lt_u32 s54, s83
    s_cbranch_scc1 L_dr_k
    ds_write_b32 v118, v119 offset:16
    s_mov_b32 s78, 0
    s_mov_b32 s85, 2
    s_mov_b32 s53, 32768
    s_mov_b32 s51, 0
    s_branch L_dd_k_e
L_de_v:
    s_cmp_eq_u32 s7, 1
    s_cbranch_scc1 L_df_v
    s_mov_b32 s10, 7
L_qs_e_v:
    s_lshl_b32 s11, s10, 2
    v_mov_b32 v48, s11
    s_mov_b32 s14, 2097152
L_ql_e_v:
    ds_read_b32 v49, v48 offset:96
    s_waitcnt lgkmcnt(0)
    v_cmp_ne_u32 vcc, 0, v49
    s_cbranch_vccnz L_qok_e_v
    s_sleep 1
    s_sub_u32 s14, s14, 1
    s_cbranch_scc0 L_ql_e_v
L_qok_e_v:
    s_and_b32 s10, s4, 7
    s_lshl_b32 s10, s10, 8
    s_add_u32 s10, s10, 16384
    s_add_u32 s48, s38, s10
    s_addc_u32 s49, s39, 0
    s_mov_b32 s72, 896
    s_mov_b32 s7, 1
    s_mov_b32 s74, s99
    s_mov_b32 s55, 0
    s_cmp_lt_u32 s82, s65
    s_cbranch_scc1 L_dnf_v
    s_mov_b32 s55, 1
    s_atomic_add s55, s[48:49], 0 glc
    s_branch L_dnf_v
L_df_v:
    ds_write_b32 v118, v119 offset:16
    s_branch L_dnf_v
L_dx_v:
    s_mov_b32 s65, 0
    s_mov_b32 s82, 0
    s_waitcnt lgkmcnt(0)
    s_add_u32 s54, s55, s72
    s_cmp_eq_u32 s7, 1
    s_cselect_b32 s83, 1408, s83
    s_cselect_b32 s84, 1, s84
    s_cmp_lt_u32 s54, s83
    s_cbranch_scc1 L_dr_v
    ds_write_b32 v118, v119 offset:16
    s_mov_b32 s78, 0
    s_mov_b32 s85, 2
    s_mov_b32 s53, 32768
    s_mov_b32 s51, 0
    s_branch L_dd_v_e
L_vlim:
    s_mov_b32 s57, s10
    s_nop 4
L_arr:
    s_cmp_ge_u32 s66, s57
    s_cbranch_scc1 L_arrd
    s_mul_i32 s9, s66, 12288
    v_add_u32 v50, s9, v55
    ds_write_b128 v50, v[20:23] offset:0
    ds_write_b128 v50, v[24:27] offset:1024
    ds_write_b128 v50, v[28:31] offset:2048
    v_add_f32_dpp v115, v115, v115 row_ror:8 row_mask:0xf bank_mask:0xf
    v_mov_b32 v49, v115
    s_nop 1
    v_permlane16_swap_b32 v115, v49
    s_nop 1
    v_add_f32 v115, v115, v49
    v_mov_b32 v49, v115
    s_nop 1
    v_permlane32_swap_b32 v115, v49
    s_nop 1
    v_add_f32 v115, v115, v49
    s_lshl_b32 s10, s66, 5
    v_mov_b32 v51, s10
    s_lshl_b32 s11, s3, 2
    v_add_u32 v49, s11, v51
    s_lshl_b32 s10, s66, 2
    v_mov_b32 v48, s10
    s_mov_b64 exec, 1
    ds_write_b32 v49, v114 offset:29440
    ds_write_b32 v49, v115 offset:29456
    ds_add_rtn_u32 v49, v48, v119 offset:64
    s_mov_b64 exec, -1
    s_mov_b32 s101, s66
    s_add_u32 s66, s66, 1
    s_nop 1
    v_mov_b32 v20, 0
    v_mov_b32 v21, 0
    v_mov_b32 v22, 0
    v_mov_b32 v23, 0
    v_mov_b32 v24, 0
    v_mov_b32 v25, 0
    v_mov_b32 v26, 0
    v_mov_b32 v27, 0
    v_mov_b32 v28, 0
    v_mov_b32 v29, 0
    v_mov_b32 v30, 0
    v_mov_b32 v31, 0
    v_mov_b32 v114, 0xff61b1e6
    v_mov_b32 v115, 0
    s_waitcnt lgkmcnt(0)
    s_cmp_lt_u32 s101, 6
    s_cbranch_scc1 L_arr
    v_readfirstlane_b32 s11, v49
    s_cmp_lg_u32 s11, 3
    s_cbranch_scc1 L_arr
    s_lshl_b32 s10, s101, 5
    v_mov_b32 v51, s10
    s_mul_i32 s9, s101, 12288
    v_add_u32 v50, s9, v116
    ds_read_b128 v[152:155], v51 offset:29440
    ds_read_b128 v[156:159], v51 offset:29456
    ds_read_b128 v[120:123], v50 offset:0
    ds_read_b128 v[124:127], v50 offset:1664
    ds_read_b128 v[128:131], v50 offset:3072
    ds_read_b128 v[132:135], v50 offset:4736
    ds_read_b128 v[136:139], v50 offset:6144
    ds_read_b128 v[140:143], v50 offset:7808
    ds_read_b128 v[144:147], v50 offset:9216
    ds_read_b128 v[148:151], v50 offset:10880
    s_and_b32 s8, s101, 3
    s_mul_i32 s8, s8, 286720
    s_add_u32 s8, s8, s64
    s_lshl_b32 s9, s100, 9
    s_add_u32 s8, s8, s9
    s_and_b32 s9, s4, 7
    s_mul_i32 s9, s9, 35840
    s_and_b32 s10, s4, 24
    s_add_u32 s10, s10, s5
    s_lshl_b32 s10, s10, 9
    s_add_u32 s9, s9, s10
    s_add_u32 s9, s9, 4005888
    s_cmp_eq_u32 s101, 7
    s_cselect_b32 s8, s9, s8
    s_add_u32 s8, s8, 7168
    s_mov_b32 s10, s101
L_qs_z:
    s_lshl_b32 s11, s10, 2
    v_mov_b32 v48, s11
    s_mov_b32 s14, 2097152
L_ql_z:
    ds_read_b32 v49, v48 offset:96
    s_waitcnt lgkmcnt(0)
    v_cmp_ne_u32 vcc, 0, v49
    s_cbranch_vccnz L_qok_z
    s_sleep 1
    s_sub_u32 s14, s14, 1
    s_cbranch_scc0 L_ql_z
L_qok_z:
    v_max3_f32 v48, v152, v153, v154
    v_max_f32 v48, v48, v155
    v_sub_f32 v152, v152, v48
    v_sub_f32 v153, v153, v48
    v_sub_f32 v154, v154, v48
    v_sub_f32 v155, v155, v48
    v_mul_f32 v152, s59, v152
    v_mul_f32 v153, s59, v153
    v_mul_f32 v154, s59, v154
    v_mul_f32 v155, s59, v155
    v_exp_f32 v152, v152
    v_exp_f32 v153, v153
    v_exp_f32 v154, v154
    v_exp_f32 v155, v155
    v_pk_add_f32 v[120:121], v[120:121], v[124:125]
    v_pk_add_f32 v[122:123], v[122:123], v[126:127]
    v_pk_add_f32 v[128:129], v[128:129], v[132:133]
    v_pk_add_f32 v[130:131], v[130:131], v[134:135]
    v_pk_add_f32 v[136:137], v[136:137], v[140:141]
    v_pk_add_f32 v[138:139], v[138:139], v[142:143]
    v_pk_add_f32 v[144:145], v[144:145], v[148:149]
    v_pk_add_f32 v[146:147], v[146:147], v[150:151]
    v_mul_f32 v120, v120, v152
    v_mul_f32 v121, v121, v152
    v_mul_f32 v122, v122, v152
    v_mul_f32 v123, v123, v152
    v_fmac_f32 v120, v128, v153
    v_fmac_f32 v121, v129, v153
    v_fmac_f32 v122, v130, v153
    v_fmac_f32 v123, v131, v153
    v_fmac_f32 v120, v136, v154
    v_fmac_f32 v121, v137, v154
    v_fmac_f32 v122, v138, v154
    v_fmac_f32 v123, v139, v154
    v_fmac_f32 v120, v144, v155
    v_fmac_f32 v121, v145, v155
    v_fmac_f32 v122, v146, v155
    v_fmac_f32 v123, v147, v155
    v_cvt_pk_bf16_f32 v120, v120, v121
    v_cvt_pk_bf16_f32 v121, v122, v123
    v_mul_f32 v50, v156, v152
    v_fmac_f32 v50, v157, v153
    v_fmac_f32 v50, v158, v154
    v_fmac_f32 v50, v159, v155
    s_mov_b32 exec_lo, 0xf000f000
    s_mov_b32 exec_hi, 0xf000f000
    v_mov_b32 v120, v48
    v_mov_b32 v121, v50
    s_mov_b64 exec, -1
    v_min_u32 v120, -2, v120
    v_min_u32 v121, -2, v121
    buffer_store_dwordx2 v[120:121], v208, s[68:71], s8 offen sc1
    s_mov_b64 exec, 1
    ds_add_u32 v118, v119 offset:24
    s_mov_b64 exec, -1
    s_branch L_arr
L_arrd:
    s_cmp_eq_u32 s85, 1
    s_cbranch_scc1 L_vlimback
    s_cmp_lt_u32 s57, 8
    s_cbranch_scc1 L_pent
    s_endpgm
L_service:
    s_sub_u32 s7, s3, 4
    v_mov_b32 v8, 0
    v_mov_b32 v9, 0
    v_mov_b32 v10, 0
    v_mov_b32 v11, 0
    v_lshlrev_b32 v2, 4, v1
    v_lshrrev_b32 v3, 4, v1
    v_and_b32 v12, 15, v1
    v_lshlrev_b32 v12, 4, v12
    ds_write_b128 v12, v[8:11]
    v_mov_b32 v12, 8192
    s_waitcnt lgkmcnt(0)
    s_mov_b32 s68, s38
    s_mov_b32 s69, s39
    s_mov_b32 s70, 5242880
    s_mov_b32 s71, 0x00020000
    s_mov_b32 s72, s16
    s_mov_b32 s73, s17
    s_mov_b32 s74, 2560
    s_mov_b32 s75, 0x00020000
    buffer_load_dword v31, v12, s[68:71], 0 offen sc1
    s_cmp_ge_u32 s4, 24
    s_cbranch_scc1 L_sv_noq
    s_lshr_b32 s9, s4, 1
    s_lshl_b32 s9, s9, 3
    s_add_u32 s9, s9, s5
    s_lshl_b32 s9, s9, 1
    s_and_b32 s8, s4, 1
    s_add_u32 s9, s9, s8
    v_mul_u32_u24 v10, 40, v1
    buffer_load_dwordx4 v[32:35], v10, s[72:75], 0 offen
    buffer_load_dwordx4 v[36:39], v10, s[72:75], 0 offen offset:16
    buffer_load_dwordx2 v[40:41], v10, s[72:75], 0 offen offset:32
    s_mov_b32 s40, s22
    s_mov_b32 s41, s23
    s_mov_b32 s42, 7864320
    s_mov_b32 s43, 0x00020000
    v_lshrrev_b32 v11, 3, v1
    v_mul_u32_u24 v12, 20, v11
    s_mov_b32 s8, 12288
    v_mul_lo_u32 v13, v12, s8
    v_and_b32 v14, 3, v1
    v_lshl_add_u32 v13, v14, 4, v13
    s_mul_i32 s8, s7, 1966080
    s_mul_i32 s10, s9, 64
    s_add_u32 s8, s8, s10
    buffer_load_dwordx4 v[128:131], v13, s[40:43], s8 offen nt
    s_add_u32 s8, s8, 12288
    buffer_load_dwordx4 v[132:135], v13, s[40:43], s8 offen nt
    s_add_u32 s8, s8, 12288
    buffer_load_dwordx4 v[136:139], v13, s[40:43], s8 offen nt
    s_add_u32 s8, s8, 12288
    buffer_load_dwordx4 v[140:143], v13, s[40:43], s8 offen nt
    s_add_u32 s8, s8, 12288
    buffer_load_dwordx4 v[144:147], v13, s[40:43], s8 offen nt
    s_add_u32 s8, s8, 12288
    buffer_load_dwordx4 v[148:151], v13, s[40:43], s8 offen nt
    s_add_u32 s8, s8, 12288
    buffer_load_dwordx4 v[152:155], v13, s[40:43], s8 offen nt
    s_add_u32 s8, s8, 12288
    buffer_load_dwordx4 v[156:159], v13, s[40:43], s8 offen nt
    s_add_u32 s8, s8, 12288
    buffer_load_dwordx4 v[160:163], v13, s[40:43], s8 offen nt
    s_add_u32 s8, s8, 12288
    buffer_load_dwordx4 v[164:167], v13, s[40:43], s8 offen nt
    s_add_u32 s8, s8, 12288
    buffer_load_dwordx4 v[168:171], v13, s[40:43], s8 offen nt
    s_add_u32 s8, s8, 12288
    buffer_load_dwordx4 v[172:175], v13, s[40:43], s8 offen nt
    s_add_u32 s8, s8, 12288
    buffer_load_dwordx4 v[176:179], v13, s[40:43], s8 offen nt
    s_add_u32 s8, s8, 12288
    buffer_load_dwordx4 v[180:183], v13, s[40:43], s8 offen nt
    s_add_u32 s8, s8, 12288
    buffer_load_dwordx4 v[184:187], v13, s[40:43], s8 offen nt
    s_add_u32 s8, s8, 12288
    buffer_load_dwordx4 v[188:191], v13, s[40:43], s8 offen nt
    s_add_u32 s8, s8, 12288
    buffer_load_dwordx4 v[192:195], v13, s[40:43], s8 offen nt
    s_add_u32 s8, s8, 12288
    buffer_load_dwordx4 v[196:199], v13, s[40:43], s8 offen nt
    s_add_u32 s8, s8, 12288
    buffer_load_dwordx4 v[200:203], v13, s[40:43], s8 offen nt
    s_add_u32 s8, s8, 12288
    buffer_load_dwordx4 v[204:207], v13, s[40:43], s8 offen nt
    s_barrier
L_lateb:
    s_mul_i32 s66, s9, 171
    s_lshr_b32 s66, s66, 10
    s_mul_i32 s67, s66, 6
    s_sub_u32 s67, s9, s67
    v_and_b32 v14, 1, v1
    v_mov_b32 v15, 0xffff
    v_lshlrev_b32 v14, 4, v14
    v_lshlrev_b32 v15, v14, v15
    v_bfe_u32 v14, v1, 1, 2
    v_cmp_eq_u32 vcc, 0, v14
    s_nop 1
    v_cndmask_b32 v4, 0, v15, vcc
    v_cmp_eq_u32 vcc, 1, v14
    s_nop 1
    v_cndmask_b32 v5, 0, v15, vcc
    v_cmp_eq_u32 vcc, 2, v14
    s_nop 1
    v_cndmask_b32 v6, 0, v15, vcc
    v_cmp_eq_u32 vcc, 3, v14
    s_nop 1
    v_cndmask_b32 v7, 0, v15, vcc
    v_mov_b32 v208, -1
    v_mov_b32 v209, -1
    v_mov_b32 v210, -1
    v_mov_b32 v211, -1
    s_waitcnt vmcnt(20)
    s_lshl_b32 s10, s67, 2
    s_add_u32 s10, s10, s7
    s_cmp_ge_u32 s66, 16
    s_cselect_b32 s8, 8, 2
    s_cmp_ge_u32 s10, s8
    s_cbranch_scc1 L_cl3
    s_cmp_ge_u32 s10, 2
    s_cselect_b32 s8, 1024, 0
    s_mul_i32 s10, s10, 3072
    s_add_u32 s10, s10, s8
    s_mul_i32 s8, s66, 35840
    s_add_u32 s8, s8, s10
    s_add_u32 s8, s8, 3145728
    buffer_store_dwordx4 v[208:211], v2, s[68:71], s8 offen offset:0 sc1
    buffer_store_dwordx4 v[208:211], v2, s[68:71], s8 offen offset:1024 sc1
    buffer_store_dwordx4 v[208:211], v2, s[68:71], s8 offen offset:2048 sc1
    s_branch L_cl_done
L_cl3:
    s_cmp_lg_u32 s67, 5
    s_cbranch_scc1 L_cl_done
    s_cmp_lt_u32 s66, 24
    s_cbranch_scc1 L_cl4
    s_lshl_b32 s8, s66, 8
    s_add_u32 s8, s8, 10240
    v_mov_b32 v213, 0
    buffer_store_dword v213, v213, s[68:71], s8 offen sc1
L_cl4:
    s_cmp_ge_u32 s66, 6
    s_cbranch_scc1 L_cl_done
    s_lshl_b32 s8, s66, 14
    s_lshl_b32 s10, s7, 12
    s_add_u32 s8, s8, s10
    s_add_u32 s8, s8, 786432
    buffer_store_dwordx4 v[208:211], v2, s[68:71], s8 offen offset:0 sc1
    buffer_store_dwordx4 v[208:211], v2, s[68:71], s8 offen offset:1024 sc1
    buffer_store_dwordx4 v[208:211], v2, s[68:71], s8 offen offset:2048 sc1
    buffer_store_dwordx4 v[208:211], v2, s[68:71], s8 offen offset:3072 sc1
L_cl_done:
    v_lshlrev_b32 v44, 16, v32
    v_and_b32 v45, 0xffff0000, v32
    v_lshlrev_b32 v46, 16, v33
    v_and_b32 v47, 0xffff0000, v33
    v_lshlrev_b32 v48, 16, v34
    v_and_b32 v49, 0xffff0000, v34
    v_lshlrev_b32 v50, 16, v35
    v_and_b32 v51, 0xffff0000, v35
    v_lshlrev_b32 v52, 16, v36
    v_and_b32 v53, 0xffff0000, v36
    v_lshlrev_b32 v54, 16, v37
    v_and_b32 v55, 0xffff0000, v37
    v_lshlrev_b32 v56, 16, v38
    v_and_b32 v57, 0xffff0000, v38
    v_lshlrev_b32 v58, 16, v39
    v_and_b32 v59, 0xffff0000, v39
    v_lshlrev_b32 v60, 16, v40
    v_and_b32 v61, 0xffff0000, v40
    v_lshlrev_b32 v62, 16, v41
    v_and_b32 v63, 0xffff0000, v41
    v_pk_add_f32 v[64:65], v[44:45], v[46:47]
    v_pk_add_f32 v[66:67], v[48:49], v[50:51]
    v_pk_add_f32 v[64:65], v[64:65], v[52:53]
    v_pk_add_f32 v[66:67], v[66:67], v[54:55]
    v_pk_add_f32 v[64:65], v[64:65], v[56:57]
    v_pk_add_f32 v[66:67], v[66:67], v[58:59]
    v_pk_add_f32 v[64:65], v[64:65], v[60:61]
    v_pk_add_f32 v[66:67], v[66:67], v[62:63]
    v_pk_add_f32 v[64:65], v[64:65], v[66:67]
    v_add_f32 v64, v64, v65
    s_nop 1
    v_add_f32_dpp v64, v64, v64 row_ror:8 row_mask:0xf bank_mask:0xf
    s_nop 1
    v_add_f32_dpp v64, v64, v64 row_ror:4 row_mask:0xf bank_mask:0xf
    s_nop 1
    v_add_f32_dpp v64, v64, v64 row_ror:2 row_mask:0xf bank_mask:0xf
    s_nop 1
    v_add_f32_dpp v64, v64, v64 row_ror:1 row_mask:0xf bank_mask:0xf
    v_mov_b32 v66, v64
    s_nop 1
    v_permlane16_swap_b32 v64, v66
    s_nop 1
    v_add_f32 v64, v64, v66
    v_mul_f32 v68, 0xbacccccd, v64
    v_mul_f32 v69, 0xbacccccd, v64
    v_pk_add_f32 v[66:67], v[44:45], v[68:69]
    v_pk_mul_f32 v[64:65], v[66:67], v[66:67]
    v_pk_add_f32 v[70:71], v[46:47], v[68:69]
    v_pk_fma_f32 v[64:65], v[70:71], v[70:71], v[64:65]
    v_pk_add_f32 v[66:67], v[48:49], v[68:69]
    v_pk_fma_f32 v[64:65], v[66:67], v[66:67], v[64:65]
    v_pk_add_f32 v[70:71], v[50:51], v[68:69]
    v_pk_fma_f32 v[64:65], v[70:71], v[70:71], v[64:65]
    v_pk_add_f32 v[66:67], v[52:53], v[68:69]
    v_pk_fma_f32 v[64:65], v[66:67], v[66:67], v[64:65]
    v_pk_add_f32 v[70:71], v[54:55], v[68:69]
    v_pk_fma_f32 v[64:65], v[70:71], v[70:71], v[64:65]
    v_pk_add_f32 v[66:67], v[56:57], v[68:69]
    v_pk_fma_f32 v[64:65], v[66:67], v[66:67], v[64:65]
    v_pk_add_f32 v[70:71], v[58:59], v[68:69]
    v_pk_fma_f32 v[64:65], v[70:71], v[70:71], v[64:65]
    v_pk_add_f32 v[66:67], v[60:61], v[68:69]
    v_pk_fma_f32 v[64:65], v[66:67], v[66:67], v[64:65]
    v_pk_add_f32 v[70:71], v[62:63], v[68:69]
    v_pk_fma_f32 v[64:65], v[70:71], v[70:71], v[64:65]
    v_add_f32 v64, v64, v65
    v_cvt_pk_bf16_f32 v68, v68, v68
    v_lshlrev_b32 v68, 16, v68
    v_add_f32_dpp v64, v64, v64 row_ror:8 row_mask:0xf bank_mask:0xf
    v_mov_b32 v69, v68
    v_pk_add_f32 v[44:45], v[44:45], v[68:69]
    v_add_f32_dpp v64, v64, v64 row_ror:4 row_mask:0xf bank_mask:0xf
    v_pk_add_f32 v[46:47], v[46:47], v[68:69]
    v_pk_add_f32 v[48:49], v[48:49], v[68:69]
    v_add_f32_dpp v64, v64, v64 row_ror:2 row_mask:0xf bank_mask:0xf
    v_pk_add_f32 v[50:51], v[50:51], v[68:69]
    v_pk_add_f32 v[52:53], v[52:53], v[68:69]
    v_add_f32_dpp v64, v64, v64 row_ror:1 row_mask:0xf bank_mask:0xf
    v_pk_add_f32 v[54:55], v[54:55], v[68:69]
    v_pk_add_f32 v[56:57], v[56:57], v[68:69]
    v_mov_b32 v66, v64
    v_pk_add_f32 v[58:59], v[58:59], v[68:69]
    v_pk_add_f32 v[60:61], v[60:61], v[68:69]
    v_permlane16_swap_b32 v64, v66
    v_pk_add_f32 v[62:63], v[62:63], v[68:69]
    v_cvt_pk_bf16_f32 v44, v44, v45
    v_add_f32 v64, v64, v66
    v_mul_f32 v70, 0x3acccccd, v64
    v_cvt_pk_bf16_f32 v70, v70, v70
    v_lshlrev_b32 v70, 16, v70
    v_add_f32 v70, 0x3727c5ac, v70
    v_cvt_pk_bf16_f32 v70, v70, v70
    v_lshlrev_b32 v70, 16, v70
    v_sqrt_f32 v70, v70
    v_cvt_pk_bf16_f32 v46, v46, v47
    v_cvt_pk_bf16_f32 v70, v70, v70
    v_lshlrev_b32 v70, 16, v70
    v_rcp_f32 v70, v70
    v_cvt_pk_bf16_f32 v48, v48, v49
    v_mov_b32 v71, v70
    v_cvt_pk_bf16_f32 v50, v50, v51
    v_cvt_pk_bf16_f32 v52, v52, v53
    v_cvt_pk_bf16_f32 v54, v54, v55
    v_cvt_pk_bf16_f32 v56, v56, v57
    v_cvt_pk_bf16_f32 v58, v58, v59
    v_cvt_pk_bf16_f32 v60, v60, v61
    v_cvt_pk_bf16_f32 v62, v62, v63
    v_and_b32 v45, 0xffff0000, v44
    v_lshlrev_b32 v44, 16, v44
    v_and_b32 v47, 0xffff0000, v46
    v_lshlrev_b32 v46, 16, v46
    v_and_b32 v49, 0xffff0000, v48
    v_lshlrev_b32 v48, 16, v48
    v_and_b32 v51, 0xffff0000, v50
    v_lshlrev_b32 v50, 16, v50
    v_and_b32 v53, 0xffff0000, v52
    v_lshlrev_b32 v52, 16, v52
    v_and_b32 v55, 0xffff0000, v54
    v_lshlrev_b32 v54, 16, v54
    v_and_b32 v57, 0xffff0000, v56
    v_lshlrev_b32 v56, 16, v56
    v_and_b32 v59, 0xffff0000, v58
    v_lshlrev_b32 v58, 16, v58
    v_and_b32 v61, 0xffff0000, v60
    v_lshlrev_b32 v60, 16, v60
    v_and_b32 v63, 0xffff0000, v62
    v_lshlrev_b32 v62, 16, v62
    v_pk_mul_f32 v[44:45], v[44:45], v[70:71]
    v_pk_mul_f32 v[46:47], v[46:47], v[70:71]
    v_pk_mul_f32 v[48:49], v[48:49], v[70:71]
    v_pk_mul_f32 v[50:51], v[50:51], v[70:71]
    v_pk_mul_f32 v[52:53], v[52:53], v[70:71]
    v_pk_mul_f32 v[54:55], v[54:55], v[70:71]
    v_pk_mul_f32 v[56:57], v[56:57], v[70:71]
    v_pk_mul_f32 v[58:59], v[58:59], v[70:71]
    v_pk_mul_f32 v[60:61], v[60:61], v[70:71]
    v_pk_mul_f32 v[62:63], v[62:63], v[70:71]
    v_cvt_pk_bf16_f32 v72, v44, v44
    v_cvt_pk_bf16_f32 v73, v45, v45
    v_cvt_pk_bf16_f32 v74, v46, v46
    v_cvt_pk_bf16_f32 v75, v47, v47
    v_cvt_pk_bf16_f32 v76, v48, v48
    v_cvt_pk_bf16_f32 v77, v49, v49
    v_cvt_pk_bf16_f32 v78, v50, v50
    v_cvt_pk_bf16_f32 v79, v51, v51
    v_cvt_pk_bf16_f32 v80, v52, v52
    v_cvt_pk_bf16_f32 v81, v53, v53
    v_cvt_pk_bf16_f32 v82, v54, v54
    v_cvt_pk_bf16_f32 v83, v55, v55
    v_cvt_pk_bf16_f32 v84, v56, v56
    v_cvt_pk_bf16_f32 v85, v57, v57
    v_cvt_pk_bf16_f32 v86, v58, v58
    v_cvt_pk_bf16_f32 v87, v59, v59
    v_cvt_pk_bf16_f32 v88, v60, v60
    v_cvt_pk_bf16_f32 v89, v61, v61
    v_cvt_pk_bf16_f32 v90, v62, v62
    v_cvt_pk_bf16_f32 v91, v63, v63
    v_mul_u32_u24 v14, 80, v1
    ds_write_b128 v14, v[72:75] offset:256
    ds_write_b128 v14, v[76:79] offset:272
    ds_write_b128 v14, v[80:83] offset:288
    ds_write_b128 v14, v[84:87] offset:304
    ds_write_b128 v14, v[88:91] offset:320
    s_mul_i32 s8, s7, 640
    v_lshlrev_b32 v14, 2, v12
    v_add_u32 v14, s8, v14
    s_waitcnt lgkmcnt(0)
    ds_read_b128 v[72:75], v14 offset:256
    ds_read_b128 v[76:79], v14 offset:272
    ds_read_b128 v[80:83], v14 offset:288
    ds_read_b128 v[84:87], v14 offset:304
    ds_read_b128 v[88:91], v14 offset:320
    ds_read_b128 v[92:95], v14 offset:2816
    ds_read_b128 v[96:99], v14 offset:2832
    ds_read_b128 v[100:103], v14 offset:2848
    ds_read_b128 v[104:107], v14 offset:2864
    ds_read_b128 v[108:111], v14 offset:2880
    s_waitcnt lgkmcnt(0)
    v_and_b32 v120, v72, v4
    v_and_b32 v121, v72, v5
    v_and_b32 v122, v72, v6
    v_and_b32 v123, v72, v7
    v_and_b32 v124, v92, v4
    v_and_b32 v125, v92, v5
    v_and_b32 v126, v92, v6
    v_and_b32 v127, v92, v7
    s_waitcnt vmcnt(19)
    s_nop 0
    v_mfma_f32_16x16x32_bf16 v[112:115], v[128:131], v[120:123], 0
    v_mfma_f32_16x16x32_bf16 v[116:119], v[128:131], v[124:127], 0
    v_and_b32 v120, v73, v4
    v_and_b32 v121, v73, v5
    v_and_b32 v122, v73, v6
    v_and_b32 v123, v73, v7
    v_and_b32 v124, v93, v4
    v_and_b32 v125, v93, v5
    v_and_b32 v126, v93, v6
    v_and_b32 v127, v93, v7
    s_waitcnt vmcnt(18)
    s_nop 0
    v_mfma_f32_16x16x32_bf16 v[112:115], v[132:135], v[120:123], v[112:115]
    v_mfma_f32_16x16x32_bf16 v[116:119], v[132:135], v[124:127], v[116:119]
    v_and_b32 v120, v74, v4
    v_and_b32 v121, v74, v5
    v_and_b32 v122, v74, v6
    v_and_b32 v123, v74, v7
    v_and_b32 v124, v94, v4
    v_and_b32 v125, v94, v5
    v_and_b32 v126, v94, v6
    v_and_b32 v127, v94, v7
    s_waitcnt vmcnt(17)
    s_nop 0
    v_mfma_f32_16x16x32_bf16 v[112:115], v[136:139], v[120:123], v[112:115]
    v_mfma_f32_16x16x32_bf16 v[116:119], v[136:139], v[124:127], v[116:119]
    v_and_b32 v120, v75, v4
    v_and_b32 v121, v75, v5
    v_and_b32 v122, v75, v6
    v_and_b32 v123, v75, v7
    v_and_b32 v124, v95, v4
    v_and_b32 v125, v95, v5
    v_and_b32 v126, v95, v6
    v_and_b32 v127, v95, v7
    s_waitcnt vmcnt(16)
    s_nop 0
    v_mfma_f32_16x16x32_bf16 v[112:115], v[140:143], v[120:123], v[112:115]
    v_mfma_f32_16x16x32_bf16 v[116:119], v[140:143], v[124:127], v[116:119]
    v_and_b32 v120, v76, v4
    v_and_b32 v121, v76, v5
    v_and_b32 v122, v76, v6
    v_and_b32 v123, v76, v7
    v_and_b32 v124, v96, v4
    v_and_b32 v125, v96, v5
    v_and_b32 v126, v96, v6
    v_and_b32 v127, v96, v7
    s_waitcnt vmcnt(15)
    s_nop 0
    v_mfma_f32_16x16x32_bf16 v[112:115], v[144:147], v[120:123], v[112:115]
    v_mfma_f32_16x16x32_bf16 v[116:119], v[144:147], v[124:127], v[116:119]
    v_and_b32 v120, v77, v4
    v_and_b32 v121, v77, v5
    v_and_b32 v122, v77, v6
    v_and_b32 v123, v77, v7
    v_and_b32 v124, v97, v4
    v_and_b32 v125, v97, v5
    v_and_b32 v126, v97, v6
    v_and_b32 v127, v97, v7
    s_waitcnt vmcnt(14)
    s_nop 0
    v_mfma_f32_16x16x32_bf16 v[112:115], v[148:151], v[120:123], v[112:115]
    v_mfma_f32_16x16x32_bf16 v[116:119], v[148:151], v[124:127], v[116:119]
    v_and_b32 v120, v78, v4
    v_and_b32 v121, v78, v5
    v_and_b32 v122, v78, v6
    v_and_b32 v123, v78, v7
    v_and_b32 v124, v98, v4
    v_and_b32 v125, v98, v5
    v_and_b32 v126, v98, v6
    v_and_b32 v127, v98, v7
    s_waitcnt vmcnt(13)
    s_nop 0
    v_mfma_f32_16x16x32_bf16 v[112:115], v[152:155], v[120:123], v[112:115]
    v_mfma_f32_16x16x32_bf16 v[116:119], v[152:155], v[124:127], v[116:119]
    v_and_b32 v120, v79, v4
    v_and_b32 v121, v79, v5
    v_and_b32 v122, v79, v6
    v_and_b32 v123, v79, v7
    v_and_b32 v124, v99, v4
    v_and_b32 v125, v99, v5
    v_and_b32 v126, v99, v6
    v_and_b32 v127, v99, v7
    s_waitcnt vmcnt(12)
    s_nop 0
    v_mfma_f32_16x16x32_bf16 v[112:115], v[156:159], v[120:123], v[112:115]
    v_mfma_f32_16x16x32_bf16 v[116:119], v[156:159], v[124:127], v[116:119]
    v_and_b32 v120, v80, v4
    v_and_b32 v121, v80, v5
    v_and_b32 v122, v80, v6
    v_and_b32 v123, v80, v7
    v_and_b32 v124, v100, v4
    v_and_b32 v125, v100, v5
    v_and_b32 v126, v100, v6
    v_and_b32 v127, v100, v7
    s_waitcnt vmcnt(11)
    s_nop 0
    v_mfma_f32_16x16x32_bf16 v[112:115], v[160:163], v[120:123], v[112:115]
    v_mfma_f32_16x16x32_bf16 v[116:119], v[160:163], v[124:127], v[116:119]
    v_and_b32 v120, v81, v4
    v_and_b32 v121, v81, v5
    v_and_b32 v122, v81, v6
    v_and_b32 v123, v81, v7
    v_and_b32 v124, v101, v4
    v_and_b32 v125, v101, v5
    v_and_b32 v126, v101, v6
    v_and_b32 v127, v101, v7
    s_waitcnt vmcnt(10)
    s_nop 0
    v_mfma_f32_16x16x32_bf16 v[112:115], v[164:167], v[120:123], v[112:115]
    v_mfma_f32_16x16x32_bf16 v[116:119], v[164:167], v[124:127], v[116:119]
    v_and_b32 v120, v82, v4
    v_and_b32 v121, v82, v5
    v_and_b32 v122, v82, v6
    v_and_b32 v123, v82, v7
    v_and_b32 v124, v102, v4
    v_and_b32 v125, v102, v5
    v_and_b32 v126, v102, v6
    v_and_b32 v127, v102, v7
    s_waitcnt vmcnt(9)
    s_nop 0
    v_mfma_f32_16x16x32_bf16 v[112:115], v[168:171], v[120:123], v[112:115]
    v_mfma_f32_16x16x32_bf16 v[116:119], v[168:171], v[124:127], v[116:119]
    v_and_b32 v120, v83, v4
    v_and_b32 v121, v83, v5
    v_and_b32 v122, v83, v6
    v_and_b32 v123, v83, v7
    v_and_b32 v124, v103, v4
    v_and_b32 v125, v103, v5
    v_and_b32 v126, v103, v6
    v_and_b32 v127, v103, v7
    s_waitcnt vmcnt(8)
    s_nop 0
    v_mfma_f32_16x16x32_bf16 v[112:115], v[172:175], v[120:123], v[112:115]
    v_mfma_f32_16x16x32_bf16 v[116:119], v[172:175], v[124:127], v[116:119]
    v_and_b32 v120, v84, v4
    v_and_b32 v121, v84, v5
    v_and_b32 v122, v84, v6
    v_and_b32 v123, v84, v7
    v_and_b32 v124, v104, v4
    v_and_b32 v125, v104, v5
    v_and_b32 v126, v104, v6
    v_and_b32 v127, v104, v7
    s_waitcnt vmcnt(7)
    s_nop 0
    v_mfma_f32_16x16x32_bf16 v[112:115], v[176:179], v[120:123], v[112:115]
    v_mfma_f32_16x16x32_bf16 v[116:119], v[176:179], v[124:127], v[116:119]
    v_and_b32 v120, v85, v4
    v_and_b32 v121, v85, v5
    v_and_b32 v122, v85, v6
    v_and_b32 v123, v85, v7
    v_and_b32 v124, v105, v4
    v_and_b32 v125, v105, v5
    v_and_b32 v126, v105, v6
    v_and_b32 v127, v105, v7
    s_waitcnt vmcnt(6)
    s_nop 0
    v_mfma_f32_16x16x32_bf16 v[112:115], v[180:183], v[120:123], v[112:115]
    v_mfma_f32_16x16x32_bf16 v[116:119], v[180:183], v[124:127], v[116:119]
    v_and_b32 v120, v86, v4
    v_and_b32 v121, v86, v5
    v_and_b32 v122, v86, v6
    v_and_b32 v123, v86, v7
    v_and_b32 v124, v106, v4
    v_and_b32 v125, v106, v5
    v_and_b32 v126, v106, v6
    v_and_b32 v127, v106, v7
    s_waitcnt vmcnt(5)
    s_nop 0
    v_mfma_f32_16x16x32_bf16 v[112:115], v[184:187], v[120:123], v[112:115]
    v_mfma_f32_16x16x32_bf16 v[116:119], v[184:187], v[124:127], v[116:119]
    v_and_b32 v120, v87, v4
    v_and_b32 v121, v87, v5
    v_and_b32 v122, v87, v6
    v_and_b32 v123, v87, v7
    v_and_b32 v124, v107, v4
    v_and_b32 v125, v107, v5
    v_and_b32 v126, v107, v6
    v_and_b32 v127, v107, v7
    s_waitcnt vmcnt(4)
    s_nop 0
    v_mfma_f32_16x16x32_bf16 v[112:115], v[188:191], v[120:123], v[112:115]
    v_mfma_f32_16x16x32_bf16 v[116:119], v[188:191], v[124:127], v[116:119]
    v_and_b32 v120, v88, v4
    v_and_b32 v121, v88, v5
    v_and_b32 v122, v88, v6
    v_and_b32 v123, v88, v7
    v_and_b32 v124, v108, v4
    v_and_b32 v125, v108, v5
    v_and_b32 v126, v108, v6
    v_and_b32 v127, v108, v7
    s_waitcnt vmcnt(3)
    s_nop 0
    v_mfma_f32_16x16x32_bf16 v[112:115], v[192:195], v[120:123], v[112:115]
    v_mfma_f32_16x16x32_bf16 v[116:119], v[192:195], v[124:127], v[116:119]
    v_and_b32 v120, v89, v4
    v_and_b32 v121, v89, v5
    v_and_b32 v122, v89, v6
    v_and_b32 v123, v89, v7
    v_and_b32 v124, v109, v4
    v_and_b32 v125, v109, v5
    v_and_b32 v126, v109, v6
    v_and_b32 v127, v109, v7
    s_waitcnt vmcnt(2)
    s_nop 0
    v_mfma_f32_16x16x32_bf16 v[112:115], v[196:199], v[120:123], v[112:115]
    v_mfma_f32_16x16x32_bf16 v[116:119], v[196:199], v[124:127], v[116:119]
    v_and_b32 v120, v90, v4
    v_and_b32 v121, v90, v5
    v_and_b32 v122, v90, v6
    v_and_b32 v123, v90, v7
    v_and_b32 v124, v110, v4
    v_and_b32 v125, v110, v5
    v_and_b32 v126, v110, v6
    v_and_b32 v127, v110, v7
    s_waitcnt vmcnt(1)
    s_nop 0
    v_mfma_f32_16x16x32_bf16 v[112:115], v[200:203], v[120:123], v[112:115]
    v_mfma_f32_16x16x32_bf16 v[116:119], v[200:203], v[124:127], v[116:119]
    v_and_b32 v120, v91, v4
    v_and_b32 v121, v91, v5
    v_and_b32 v122, v91, v6
    v_and_b32 v123, v91, v7
    v_and_b32 v124, v111, v4
    v_and_b32 v125, v111, v5
    v_and_b32 v126, v111, v6
    v_and_b32 v127, v111, v7
    s_waitcnt vmcnt(0)
    s_nop 0
    v_mfma_f32_16x16x32_bf16 v[112:115], v[204:207], v[120:123], v[112:115]
    v_mfma_f32_16x16x32_bf16 v[116:119], v[204:207], v[124:127], v[116:119]
    s_lshl_b32 s8, s7, 11
    v_add_u32 v14, s8, v2
    s_nop 7
    ds_write_b128 v14, v[112:115] offset:5376
    ds_write_b128 v14, v[116:119] offset:6400
    v_and_b32 v16, 7, v1
    v_lshlrev_b32 v16, 4, v16
    v_bfe_u32 v17, v1, 3, 2
    v_lshl_add_u32 v16, v17, 2, v16
    v_mov_b32 v14, 0
    v_mov_b32 v15, 1
    s_waitcnt lgkmcnt(0)
    s_mov_b64 exec, 1
    ds_add_u32 v14, v15 offset:20
    s_mov_b64 exec, -1
    s_cmp_lg_u32 s7, 0
    s_cbranch_scc1 L_sv_common
    s_mov_b32 s14, 4194304
L_qspin:
    ds_read_b32 v17, v14 offset:20
    s_waitcnt lgkmcnt(0)
    v_cmp_eq_u32 vcc, 4, v17
    s_cbranch_vccnz L_qspin_done
    s_sub_u32 s14, s14, 1
    s_cbranch_scc0 L_qspin
L_qspin_done:
    ds_read_b32 v72, v16 offset:5376
    ds_read_b32 v73, v16 offset:6016
    ds_read_b32 v74, v16 offset:7424
    ds_read_b32 v75, v16 offset:8064
    ds_read_b32 v76, v16 offset:9472
    ds_read_b32 v77, v16 offset:10112
    ds_read_b32 v78, v16 offset:11520
    ds_read_b32 v79, v16 offset:12160
    ds_read_b32 v80, v16 offset:6400
    ds_read_b32 v81, v16 offset:7040
    ds_read_b32 v82, v16 offset:8448
    ds_read_b32 v83, v16 offset:9088
    ds_read_b32 v84, v16 offset:10496
    ds_read_b32 v85, v16 offset:11136
    ds_read_b32 v86, v16 offset:12544
    ds_read_b32 v87, v16 offset:13184
    v_lshlrev_b32 v17, 3, v1
    s_mul_i32 s8, s9, 256
    s_add_u32 s8, s8, 65536
    s_waitcnt lgkmcnt(0)
    v_add_f32 v72, v72, v73
    v_add_f32 v80, v80, v81
    v_add_f32 v72, v72, v74
    v_add_f32 v80, v80, v82
    v_add_f32 v72, v72, v75
    v_add_f32 v80, v80, v83
    v_add_f32 v72, v72, v76
    v_add_f32 v80, v80, v84
    v_add_f32 v72, v72, v77
    v_add_f32 v80, v80, v85
    v_add_f32 v72, v72, v78
    v_add_f32 v80, v80, v86
    v_add_f32 v72, v72, v79
    v_add_f32 v80, v80, v87
    v_cvt_pk_bf16_f32 v72, v72, v80
    v_add_u32 v73, 1, v31
    s_mov_b32 exec_hi, 0
    buffer_store_dwordx2 v[72:73], v17, s[68:71], s8 offen sc1
    s_mov_b64 exec, -1
    s_branch L_sv_common
L_sv_noq:
    s_barrier
    v_and_b32 v14, 1, v1
    v_mov_b32 v15, 0xffff
    v_lshlrev_b32 v14, 4, v14
    v_lshlrev_b32 v15, v14, v15
    v_bfe_u32 v14, v1, 1, 2
    v_cmp_eq_u32 vcc, 0, v14
    s_nop 1
    v_cndmask_b32 v4, 0, v15, vcc
    v_cmp_eq_u32 vcc, 1, v14
    s_nop 1
    v_cndmask_b32 v5, 0, v15, vcc
    v_cmp_eq_u32 vcc, 2, v14
    s_nop 1
    v_cndmask_b32 v6, 0, v15, vcc
    v_cmp_eq_u32 vcc, 3, v14
    s_nop 1
    v_cndmask_b32 v7, 0, v15, vcc
L_sv_common:
    v_mov_b32 v9, 0
    v_mov_b32 v15, 0
    v_mov_b32 v20, 0
    s_lshl_b32 s85, s4, 1
    s_add_u32 s8, s85, s6
    s_sub_u32 s8, s8, 53
    s_sub_u32 s9, s85, 1
    s_cmp_eq_u32 s4, 0
    s_cselect_b32 s9, 47, s9
    s_cmp_eq_u32 s6, 6
    s_cselect_b32 s85, s9, s85
    s_cmp_lt_u32 s4, 24
    s_cselect_b32 s82, 1, 4
    s_cselect_b32 s85, s85, s8
    s_cmp_lg_u32 s6, 7
    s_cbranch_scc1 L_role1
    s_and_b32 s85, s4, 7
    s_lshl_b32 s85, s85, 1
    s_bfe_u32 s8, s4, 65539
    s_add_u32 s85, s85, s8
    s_and_b32 s8, s4, 16
    s_add_u32 s85, s85, s8
    s_cmp_lt_u32 s85, 20
    s_cselect_b32 s82, 2, 3
    s_sub_u32 s8, s4, 20
    s_sub_u32 s9, s4, 4
    s_cmp_lt_u32 s8, 4
    s_cselect_b32 s82, 4, s82
    s_cselect_b32 s85, s9, s85
L_role1:
    s_cmp_lt_u32 s6, 5
    s_cselect_b32 s82, 0, s82
    s_waitcnt vmcnt(0)
    v_readfirstlane_b32 s15, v31
    s_add_u32 s15, s15, 1
    s_mov_b32 s98, -1
    v_lshlrev_b32 v12, 3, v1
    s_mul_i32 s8, s7, 384
    s_add_u32 s8, s8, 26368
    v_lshl_add_u32 v13, v1, 1, s8
    s_lshl_b32 s8, s7, 3
    s_mov_b32 s9, s5
    s_add_u32 s8, s8, s9
    s_mul_i32 s8, s8, 1536
    s_add_u32 s8, s8, 65536
    s_cmp_eq_u32 s7, 0
    s_cbranch_scc1 L_qnow
    s_lshl_b32 s9, s7, 2
    s_cmp_eq_u32 s98, 0
    s_cbranch_scc1 L_lw1_d
    v_mov_b32 v28, s9
    s_mov_b32 s14, 2097152
L_lw1:
    ds_read_b32 v29, v28 offset:92
    s_waitcnt lgkmcnt(0)
    v_cmp_eq_u32 vcc, 1, v29
    s_cbranch_vccnz L_lw1_d
    s_sleep 4
    s_sub_u32 s14, s14, 1
    s_cbranch_scc0 L_lw1
L_lw1_d:
L_qnow:
    s_mov_b32 s14, 262144
L_poll2:
    buffer_load_dwordx2 v[64:65], v12, s[68:71], s8 offen offset:0 sc1
    buffer_load_dwordx2 v[66:67], v12, s[68:71], s8 offen offset:512 sc1
    buffer_load_dwordx2 v[68:69], v12, s[68:71], s8 offen offset:1024 sc1
L_poll2_chk:
    s_waitcnt vmcnt(0)
    v_xor_b32 v14, s15, v65
    v_xor_b32 v15, s15, v67
    v_or_b32 v14, v14, v15
    v_xor_b32 v15, s15, v69
    v_or_b32 v14, v14, v15
    v_cmp_ne_u32 vcc, 0, v14
    s_cbranch_vccz L_poll2_done
    s_mov_b64 exec, vcc
    s_sleep 4
    s_sub_u32 s14, s14, 1
    s_cbranch_scc0 L_poll2
L_poll2_done:
    s_mov_b64 exec, -1
    ds_write_b16 v13, v64 offset:0
    ds_write_b16 v13, v66 offset:128
    ds_write_b16 v13, v68 offset:256
    s_lshl_b32 s8, s7, 2
    v_mov_b32 v16, s8
    v_mov_b32 v17, 1
    ds_write_b32 v16, v17 offset:96
    s_cmp_lg_u32 s7, 3
    s_cbranch_scc1 L_q2
    s_and_b32 s8, s4, 7
    s_mul_i32 s8, s8, 1536
    s_add_u32 s8, s8, 102400
    s_waitcnt lgkmcnt(0)
    s_mov_b32 s14, 262144
L_poll3:
    buffer_load_dwordx2 v[64:65], v12, s[68:71], s8 offen offset:0 sc1
    buffer_load_dwordx2 v[66:67], v12, s[68:71], s8 offen offset:512 sc1
    buffer_load_dwordx2 v[68:69], v12, s[68:71], s8 offen offset:1024 sc1
L_poll3_chk:
    s_waitcnt vmcnt(0)
    v_xor_b32 v14, s15, v65
    v_xor_b32 v15, s15, v67
    v_or_b32 v14, v14, v15
    v_xor_b32 v15, s15, v69
    v_or_b32 v14, v14, v15
    v_cmp_ne_u32 vcc, 0, v14
    s_cbranch_vccz L_poll3_done
    s_mov_b64 exec, vcc
    s_sleep 16
    s_sub_u32 s14, s14, 1
    s_cbranch_scc0 L_poll3
L_poll3_done:
    s_mov_b64 exec, -1
L_q2:
    ds_write_b16_d16_hi v13, v64 offset:1536
    ds_write_b16_d16_hi v13, v66 offset:1664
    ds_write_b16_d16_hi v13, v68 offset:1792
    ds_write_b32 v16, v17 offset:112
L_nogq:
    s_cmp_eq_u32 s82, 3
    s_cbranch_scc1 L_tail
L_chkall:
    s_cmp_lg_u32 s7, 0
    s_cbranch_scc1 L_chkw
    s_cmp_eq_u32 s98, 0
    s_cbranch_scc1 L_lw4_d
    v_mov_b32 v28, 0
    s_mov_b32 s14, 2097152
L_lw4:
    ds_read_b32 v29, v28 offset:64
    s_waitcnt lgkmcnt(0)
    v_cmp_eq_u32 vcc, 4, v29
    s_cbranch_vccnz L_lw4_d
    s_sleep 64
    s_sub_u32 s14, s14, 1
    s_cbranch_scc0 L_lw4
L_lw4_d:
    v_lshlrev_b32 v12, 8, v1
    s_mov_b32 s8, 65536
    s_mov_b32 s9, 81920
    s_mov_b32 s10, 98304
    s_mov_b32 s14, 262144
    buffer_load_dword v64, v12, s[68:71], s8 offen offset:252
    buffer_load_dword v65, v12, s[68:71], s9 offen offset:252
    buffer_load_dword v66, v12, s[68:71], s10 offen offset:252
    s_branch L_poll5_chk
L_poll5:
    buffer_load_dword v64, v12, s[68:71], s8 offen offset:252 sc1
    buffer_load_dword v65, v12, s[68:71], s9 offen offset:252 sc1
    buffer_load_dword v66, v12, s[68:71], s10 offen offset:252 sc1
L_poll5_chk:
    s_waitcnt vmcnt(0)
    v_xor_b32 v14, s15, v64
    v_xor_b32 v15, s15, v65
    v_or_b32 v14, v14, v15
    v_xor_b32 v15, s15, v66
    v_or_b32 v14, v14, v15
    v_cmp_ne_u32 vcc, 0, v14
    s_cbranch_vccz L_poll5_done
    s_mov_b64 exec, vcc
    s_sleep 32
    s_sub_u32 s14, s14, 1
    s_cbranch_scc0 L_poll5
L_poll5_done:
    s_mov_b64 exec, -1
    v_mov_b32 v16, 0
    v_mov_b32 v17, 1
    ds_write_b32 v16, v17 offset:28
L_chkw:
L_chkd:
    s_waitcnt vmcnt(0)
    s_mov_b32 s98, 0
L_tail:
    s_and_b32 s70, s98, 5242880
    s_and_b32 s57, s98, s15
    s_cmp_eq_u32 s98, 0
    s_cbranch_scc1 L_nopubl
    s_cmp_lg_u32 s7, 3
    s_cbranch_scc1 L_nopub7
    s_mov_b32 s64, s5
    s_mul_i32 s64, s64, 35840
    s_add_u32 s64, s64, 3145728
    s_mov_b32 s100, s4
    v_lshrrev_b32 v50, 4, v1
    v_mul_u32_u24 v50, 12, v50
    v_and_b32 v51, 15, v1
    v_min_u32 v51, 11, v51
    v_add_u32 v50, v50, v51
    v_lshlrev_b32 v117, 3, v50
    v_lshrrev_b32 v116, 3, v50
    v_lshlrev_b32 v116, 8, v116
    v_and_b32 v50, 7, v50
    v_lshl_add_u32 v116, v50, 4, v116
    v_add_u32 v116, 46080, v116
    v_lshlrev_b32 v208, 3, v1
    v_mov_b32 v118, 0
    v_mov_b32 v119, 1
    s_mov_b32 s101, 0
L_publ:
    s_lshl_b32 s8, s101, 2
    s_cmp_eq_u32 s98, 0
    s_cbranch_scc1 L_lw6_d
    v_mov_b32 v28, s8
    s_mov_b32 s14, 2097152
L_lw6:
    ds_read_b32 v29, v28 offset:64
    s_waitcnt lgkmcnt(0)
    v_cmp_eq_u32 vcc, 4, v29
    s_cbranch_vccnz L_lw6_d
    s_sleep 4
    s_sub_u32 s14, s14, 1
    s_cbranch_scc0 L_lw6
L_lw6_d:
    s_lshl_b32 s10, s101, 5
    v_mov_b32 v51, s10
    s_mul_i32 s9, s101, 12288
    v_add_u32 v50, s9, v116
    ds_read_b128 v[152:155], v51 offset:29440
    ds_read_b128 v[156:159], v51 offset:29456
    ds_read_b128 v[120:123], v50 offset:0
    ds_read_b128 v[124:127], v50 offset:1664
    ds_read_b128 v[128:131], v50 offset:3072
    ds_read_b128 v[132:135], v50 offset:4736
    ds_read_b128 v[136:139], v50 offset:6144
    ds_read_b128 v[140:143], v50 offset:7808
    ds_read_b128 v[144:147], v50 offset:9216
    ds_read_b128 v[148:151], v50 offset:10880
    s_and_b32 s8, s101, 3
    s_mul_i32 s8, s8, 286720
    s_add_u32 s8, s8, s64
    s_lshr_b32 s9, s101, 2
    s_mul_i32 s12, s9, 32
    s_add_u32 s12, s12, s100
    s_lshl_b32 s12, s12, 4
    s_add_u32 s12, s12, s8
    s_add_u32 s12, s12, 6144
    s_xor_b32 s9, s9, 1
    s_mul_i32 s9, s9, 16384
    s_add_u32 s8, s8, s9
    s_mul_i32 s9, s100, 384
    s_add_u32 s8, s8, s9
    s_add_u32 s8, s8, 7168
    s_mov_b32 s10, s101
L_qs_y:
    s_lshl_b32 s11, s10, 2
    v_mov_b32 v48, s11
    s_mov_b32 s14, 2097152
L_ql_y:
    ds_read_b32 v49, v48 offset:96
    s_waitcnt lgkmcnt(0)
    v_cmp_ne_u32 vcc, 0, v49
    s_cbranch_vccnz L_qok_y
    s_sleep 1
    s_sub_u32 s14, s14, 1
    s_cbranch_scc0 L_ql_y
L_qok_y:
    v_max3_f32 v48, v152, v153, v154
    v_max_f32 v48, v48, v155
    v_sub_f32 v152, v152, v48
    v_sub_f32 v153, v153, v48
    v_sub_f32 v154, v154, v48
    v_sub_f32 v155, v155, v48
    v_mul_f32 v152, s59, v152
    v_mul_f32 v153, s59, v153
    v_mul_f32 v154, s59, v154
    v_mul_f32 v155, s59, v155
    v_exp_f32 v152, v152
    v_exp_f32 v153, v153
    v_exp_f32 v154, v154
    v_exp_f32 v155, v155
    v_pk_add_f32 v[120:121], v[120:121], v[124:125]
    v_pk_add_f32 v[122:123], v[122:123], v[126:127]
    v_pk_add_f32 v[128:129], v[128:129], v[132:133]
    v_pk_add_f32 v[130:131], v[130:131], v[134:135]
    v_pk_add_f32 v[136:137], v[136:137], v[140:141]
    v_pk_add_f32 v[138:139], v[138:139], v[142:143]
    v_pk_add_f32 v[144:145], v[144:145], v[148:149]
    v_pk_add_f32 v[146:147], v[146:147], v[150:151]
    v_mul_f32 v120, v120, v152
    v_mul_f32 v121, v121, v152
    v_mul_f32 v122, v122, v152
    v_mul_f32 v123, v123, v152
    v_fmac_f32 v120, v128, v153
    v_fmac_f32 v121, v129, v153
    v_fmac_f32 v122, v130, v153
    v_fmac_f32 v123, v131, v153
    v_fmac_f32 v120, v136, v154
    v_fmac_f32 v121, v137, v154
    v_fmac_f32 v122, v138, v154
    v_fmac_f32 v123, v139, v154
    v_fmac_f32 v120, v144, v155
    v_fmac_f32 v121, v145, v155
    v_fmac_f32 v122, v146, v155
    v_fmac_f32 v123, v147, v155
    v_cvt_pk_bf16_f32 v120, v120, v121
    v_cvt_pk_bf16_f32 v121, v122, v123
    v_mul_f32 v50, v156, v152
    v_fmac_f32 v50, v157, v153
    v_fmac_f32 v50, v158, v154
    v_fmac_f32 v50, v159, v155
    v_min_u32 v120, -2, v120
    v_min_u32 v121, -2, v121
    v_mov_b32 v49, s15
    v_mov_b32 v51, s15
    s_mov_b32 exec_lo, 0x0fff0fff
    s_mov_b32 exec_hi, 0x0fff0fff
    buffer_store_dwordx2 v[120:121], v117, s[68:71], s8 offen sc1
    s_waitcnt vmcnt(0)
    s_mov_b64 exec, 1
    buffer_store_dwordx2 v[48:49], v118, s[68:71], s12 offen sc1
    buffer_store_dwordx2 v[50:51], v118, s[68:71], s12 offen offset:8 sc1
    ds_add_u32 v118, v119 offset:24
    s_mov_b64 exec, -1
    s_add_u32 s101, s101, 1
    s_cmp_lt_u32 s101, 6
    s_cbranch_scc1 L_publ
L_nopub7:
    s_cmp_eq_u32 s82, 3
    s_cbranch_scc1 L_end
    s_cmp_eq_u32 s98, 0
    s_cbranch_scc1 L_lw7_d
    v_mov_b32 v28, 0
    s_mov_b32 s14, 2097152
L_lw7:
    ds_read_b32 v29, v28 offset:28
    s_waitcnt lgkmcnt(0)
    v_cmp_eq_u32 vcc, 1, v29
    s_cbranch_vccnz L_lw7_d
    s_sleep 64
    s_sub_u32 s14, s14, 1
    s_cbranch_scc0 L_lw7
L_lw7_d:
L_nopubl:
    s_cmp_lg_u32 s82, 0
    s_cbranch_scc1 L_nog0
    v_and_b32 v9, 15, v1
    v_lshlrev_b32 v15, 4, v9
    v_add_u32 v15, 6144, v15
    v_mul_u32_u24 v9, 384, v9
    v_mul_u32_u24 v10, 24, v3
    v_add_u32 v9, v9, v10
    s_mul_i32 s9, s4, 35840
    s_add_u32 s13, s9, 3145728
    s_mul_i32 s10, s7, 96
    s_add_u32 s9, s9, s10
    s_add_u32 s9, s9, 3145728
    v_bfe_u32 v20, v1, 3, 1
    v_mul_u32_u24 v20, 384, v20
    v_mul_u32_u24 v10, 24, v3
    s_mul_i32 s10, s7, 96
    v_add3_u32 v20, v20, v10, s10
    s_cmp_lg_u32 s6, 0
    s_cbranch_scc1 L_nog0a
    s_lshr_b32 s10, s4, 3
    s_lshl_b32 s10, s10, 2
    s_cmp_eq_u32 s98, 0
    s_cbranch_scc1 L_lw8_d
    v_mov_b32 v28, s10
    s_mov_b32 s14, 2097152
L_lw8:
    ds_read_b32 v29, v28 offset:64
    s_waitcnt lgkmcnt(0)
    v_cmp_eq_u32 vcc, 4, v29
    s_cbranch_vccnz L_lw8_d
    s_sleep 32
    s_sub_u32 s14, s14, 1
    s_cbranch_scc0 L_lw8
L_lw8_d:
    s_add_u32 s10, s9, 23552
    s_add_u32 s11, s9, 29696
    s_mov_b32 s14, 262144
    s_mov_b32 exec_lo, 0x0000ffff
    s_mov_b32 exec_hi, 0x00000000
L_pp9:
    buffer_load_dword v188, v15, s[68:71], s13 offen offset:12 sc1
    buffer_load_dword v192, v15, s[68:71], s13 offen offset:268 sc1
    s_waitcnt vmcnt(0)
    v_xor_b32 v14, s57, v188
    v_xor_b32 v192, s57, v192
    v_or_b32 v14, v14, v192
    v_cmp_ne_u32 vcc, 0, v14
    s_bcnt1_i32_b64 s99, vcc
    s_cmp_le_u32 s99, 0
    s_cbranch_scc1 L_pp9_done
    s_sleep 64
    s_sub_u32 s14, s14, 1
    s_cbranch_scc0 L_pp9
L_pp9_done:
    s_mov_b64 exec, -1
    s_mov_b32 s14, 262144
L_poll10:
    buffer_load_dwordx4 v[188:191], v15, s[68:71], s13 offen offset:0 sc1
    buffer_load_dwordx4 v[192:195], v15, s[68:71], s13 offen offset:256 sc1
    buffer_load_dwordx4 v[176:179], v9, s[68:71], s10 offen sc1
    buffer_load_dwordx2 v[180:181], v9, s[68:71], s10 offen offset:16 sc1
    buffer_load_dwordx4 v[182:185], v9, s[68:71], s11 offen sc1
    buffer_load_dwordx2 v[186:187], v9, s[68:71], s11 offen offset:16 sc1
L_poll10_chk:
    s_waitcnt vmcnt(0)
    v_max_u32 v14, v176, v177
    v_max3_u32 v14, v14, v178, v179
    v_max3_u32 v14, v14, v180, v181
    v_max3_u32 v14, v14, v182, v183
    v_max3_u32 v14, v14, v184, v185
    v_max3_u32 v14, v14, v186, v187
    v_cmp_eq_u32 vcc, -1, v14
    v_xor_b32 v14, s57, v189
    v_xor_b32 v30, s57, v191
    v_or_b32 v14, v14, v30
    v_xor_b32 v30, s57, v193
    v_or_b32 v14, v14, v30
    v_xor_b32 v30, s57, v195
    v_or_b32 v14, v14, v30
    v_cmp_ne_u32 s[54:55], 0, v14
    s_nop 0
    s_or_b64 vcc, vcc, s[54:55]
    s_cbranch_scc0 L_poll10_done
    s_mov_b64 exec, vcc
    s_sleep 32
    s_sub_u32 s14, s14, 1
    s_cbranch_scc0 L_poll10
L_poll10_done:
    s_mov_b64 exec, -1
    v_lshlrev_b32 v224, 16, v176
    v_and_b32 v225, 0xffff0000, v176
    v_lshlrev_b32 v226, 16, v177
    v_and_b32 v227, 0xffff0000, v177
    v_lshlrev_b32 v228, 16, v178
    v_and_b32 v229, 0xffff0000, v178
    v_lshlrev_b32 v230, 16, v179
    v_and_b32 v231, 0xffff0000, v179
    v_lshlrev_b32 v232, 16, v180
    v_and_b32 v233, 0xffff0000, v180
    v_lshlrev_b32 v234, 16, v181
    v_and_b32 v235, 0xffff0000, v181
    v_lshlrev_b32 v236, 16, v182
    v_and_b32 v237, 0xffff0000, v182
    v_lshlrev_b32 v238, 16, v183
    v_and_b32 v239, 0xffff0000, v183
    v_lshlrev_b32 v240, 16, v184
    v_and_b32 v241, 0xffff0000, v184
    v_lshlrev_b32 v242, 16, v185
    v_and_b32 v243, 0xffff0000, v185
    v_lshlrev_b32 v244, 16, v186
    v_and_b32 v245, 0xffff0000, v186
    v_lshlrev_b32 v246, 16, v187
    v_and_b32 v247, 0xffff0000, v187
    v_max_f32 v16, v188, v192
    s_nop 1
    v_max_f32_dpp v16, v16, v16 row_ror:8 row_mask:0xf bank_mask:0xf
    s_nop 1
    v_max_f32_dpp v16, v16, v16 row_ror:4 row_mask:0xf bank_mask:0xf
    s_nop 1
    v_max_f32_dpp v16, v16, v16 row_ror:2 row_mask:0xf bank_mask:0xf
    s_nop 1
    v_max_f32_dpp v16, v16, v16 row_ror:1 row_mask:0xf bank_mask:0xf
    v_sub_f32 v17, v188, v16
    v_sub_f32 v18, v192, v16
    v_mul_f32 v17, s59, v17
    v_mul_f32 v18, s59, v18
    v_exp_f32 v17, v17
    v_exp_f32 v18, v18
    s_nop 0
    v_mul_f32 v16, v17, v190
    v_fmac_f32 v16, v18, v194
    v_mul_f32 v208, v224, v17
    v_mul_f32 v209, v225, v17
    v_mul_f32 v210, v226, v17
    v_mul_f32 v211, v227, v17
    v_mul_f32 v212, v228, v17
    v_mul_f32 v213, v229, v17
    v_mul_f32 v214, v230, v17
    v_mul_f32 v215, v231, v17
    v_mul_f32 v216, v232, v17
    v_mul_f32 v217, v233, v17
    v_mul_f32 v218, v234, v17
    v_mul_f32 v219, v235, v17
    v_fmac_f32 v208, v236, v18
    v_fmac_f32 v209, v237, v18
    v_fmac_f32 v210, v238, v18
    v_fmac_f32 v211, v239, v18
    v_fmac_f32 v212, v240, v18
    v_fmac_f32 v213, v241, v18
    v_fmac_f32 v214, v242, v18
    v_fmac_f32 v215, v243, v18
    v_fmac_f32 v216, v244, v18
    v_fmac_f32 v217, v245, v18
    v_fmac_f32 v218, v246, v18
    v_fmac_f32 v219, v247, v18
    v_add_f32_dpp v16, v16, v16 row_ror:8 row_mask:0xf bank_mask:0xf
    v_add_f32_dpp v208, v208, v208 row_ror:8 row_mask:0xf bank_mask:0xf
    v_add_f32_dpp v209, v209, v209 row_ror:8 row_mask:0xf bank_mask:0xf
    v_add_f32_dpp v210, v210, v210 row_ror:8 row_mask:0xf bank_mask:0xf
    v_add_f32_dpp v211, v211, v211 row_ror:8 row_mask:0xf bank_mask:0xf
    v_add_f32_dpp v212, v212, v212 row_ror:8 row_mask:0xf bank_mask:0xf
    v_add_f32_dpp v213, v213, v213 row_ror:8 row_mask:0xf bank_mask:0xf
    v_add_f32_dpp v214, v214, v214 row_ror:8 row_mask:0xf bank_mask:0xf
    v_add_f32_dpp v215, v215, v215 row_ror:8 row_mask:0xf bank_mask:0xf
    v_add_f32_dpp v216, v216, v216 row_ror:8 row_mask:0xf bank_mask:0xf
    v_add_f32_dpp v217, v217, v217 row_ror:8 row_mask:0xf bank_mask:0xf
    v_add_f32_dpp v218, v218, v218 row_ror:8 row_mask:0xf bank_mask:0xf
    v_add_f32_dpp v219, v219, v219 row_ror:8 row_mask:0xf bank_mask:0xf
    v_add_f32_dpp v16, v16, v16 row_ror:4 row_mask:0xf bank_mask:0xf
    v_add_f32_dpp v208, v208, v208 row_ror:4 row_mask:0xf bank_mask:0xf
    v_add_f32_dpp v209, v209, v209 row_ror:4 row_mask:0xf bank_mask:0xf
    v_add_f32_dpp v210, v210, v210 row_ror:4 row_mask:0xf bank_mask:0xf
    v_add_f32_dpp v211, v211, v211 row_ror:4 row_mask:0xf bank_mask:0xf
    v_add_f32_dpp v212, v212, v212 row_ror:4 row_mask:0xf bank_mask:0xf
    v_add_f32_dpp v213, v213, v213 row_ror:4 row_mask:0xf bank_mask:0xf
    v_add_f32_dpp v214, v214, v214 row_ror:4 row_mask:0xf bank_mask:0xf
    v_add_f32_dpp v215, v215, v215 row_ror:4 row_mask:0xf bank_mask:0xf
    v_add_f32_dpp v216, v216, v216 row_ror:4 row_mask:0xf bank_mask:0xf
    v_add_f32_dpp v217, v217, v217 row_ror:4 row_mask:0xf bank_mask:0xf
    v_add_f32_dpp v218, v218, v218 row_ror:4 row_mask:0xf bank_mask:0xf
    v_add_f32_dpp v219, v219, v219 row_ror:4 row_mask:0xf bank_mask:0xf
    v_add_f32_dpp v16, v16, v16 row_ror:2 row_mask:0xf bank_mask:0xf
    v_add_f32_dpp v208, v208, v208 row_ror:2 row_mask:0xf bank_mask:0xf
    v_add_f32_dpp v209, v209, v209 row_ror:2 row_mask:0xf bank_mask:0xf
    v_add_f32_dpp v210, v210, v210 row_ror:2 row_mask:0xf bank_mask:0xf
    v_add_f32_dpp v211, v211, v211 row_ror:2 row_mask:0xf bank_mask:0xf
    v_add_f32_dpp v212, v212, v212 row_ror:2 row_mask:0xf bank_mask:0xf
    v_add_f32_dpp v213, v213, v213 row_ror:2 row_mask:0xf bank_mask:0xf
    v_add_f32_dpp v214, v214, v214 row_ror:2 row_mask:0xf bank_mask:0xf
    v_add_f32_dpp v215, v215, v215 row_ror:2 row_mask:0xf bank_mask:0xf
    v_add_f32_dpp v216, v216, v216 row_ror:2 row_mask:0xf bank_mask:0xf
    v_add_f32_dpp v217, v217, v217 row_ror:2 row_mask:0xf bank_mask:0xf
    v_add_f32_dpp v218, v218, v218 row_ror:2 row_mask:0xf bank_mask:0xf
    v_add_f32_dpp v219, v219, v219 row_ror:2 row_mask:0xf bank_mask:0xf
    v_add_f32_dpp v16, v16, v16 row_ror:1 row_mask:0xf bank_mask:0xf
    v_add_f32_dpp v208, v208, v208 row_ror:1 row_mask:0xf bank_mask:0xf
    v_add_f32_dpp v209, v209, v209 row_ror:1 row_mask:0xf bank_mask:0xf
    v_add_f32_dpp v210, v210, v210 row_ror:1 row_mask:0xf bank_mask:0xf
    v_add_f32_dpp v211, v211, v211 row_ror:1 row_mask:0xf bank_mask:0xf
    v_add_f32_dpp v212, v212, v212 row_ror:1 row_mask:0xf bank_mask:0xf
    v_add_f32_dpp v213, v213, v213 row_ror:1 row_mask:0xf bank_mask:0xf
    v_add_f32_dpp v214, v214, v214 row_ror:1 row_mask:0xf bank_mask:0xf
    v_add_f32_dpp v215, v215, v215 row_ror:1 row_mask:0xf bank_mask:0xf
    v_add_f32_dpp v216, v216, v216 row_ror:1 row_mask:0xf bank_mask:0xf
    v_add_f32_dpp v217, v217, v217 row_ror:1 row_mask:0xf bank_mask:0xf
    v_add_f32_dpp v218, v218, v218 row_ror:1 row_mask:0xf bank_mask:0xf
    v_add_f32_dpp v219, v219, v219 row_ror:1 row_mask:0xf bank_mask:0xf
    v_rcp_f32 v16, v16
    s_mov_b32 exec_lo, 0x00010001
    s_mov_b32 exec_hi, 0x00010001
    v_mul_f32 v208, v208, v16
    v_mul_f32 v209, v209, v16
    v_mul_f32 v210, v210, v16
    v_mul_f32 v211, v211, v16
    v_mul_f32 v212, v212, v16
    v_mul_f32 v213, v213, v16
    v_mul_f32 v214, v214, v16
    v_mul_f32 v215, v215, v16
    v_mul_f32 v216, v216, v16
    v_mul_f32 v217, v217, v16
    v_mul_f32 v218, v218, v16
    v_mul_f32 v219, v219, v16
    v_cvt_pk_bf16_f32 v32, v208, v209
    v_cvt_pk_bf16_f32 v33, v210, v211
    v_cvt_pk_bf16_f32 v34, v212, v213
    v_cvt_pk_bf16_f32 v35, v214, v215
    v_cvt_pk_bf16_f32 v36, v216, v217
    v_cvt_pk_bf16_f32 v37, v218, v219
    v_min_u32 v32, -2, v32
    v_min_u32 v33, -2, v33
    v_min_u32 v34, -2, v34
    v_min_u32 v35, -2, v35
    v_min_u32 v36, -2, v36
    v_min_u32 v37, -2, v37
    buffer_store_dwordx4 v[32:35], v20, s[68:71], s13 offen sc1
    buffer_store_dwordx2 v[36:37], v20, s[68:71], s13 offen offset:16 sc1
    s_mov_b64 exec, -1
L_nog0a:
    s_cmp_lg_u32 s6, 1
    s_cbranch_scc1 L_nog0
    s_cmp_ge_u32 s4, 16
    s_cbranch_scc1 L_nog0
    s_lshr_b32 s10, s4, 3
    s_lshl_b32 s10, s10, 2
    s_cmp_eq_u32 s98, 0
    s_cbranch_scc1 L_lw11_d
    v_mov_b32 v28, s10
    s_mov_b32 s14, 2097152
L_lw11:
    ds_read_b32 v29, v28 offset:80
    s_waitcnt lgkmcnt(0)
    v_cmp_eq_u32 vcc, 4, v29
    s_cbranch_vccnz L_lw11_d
    s_sleep 32
    s_sub_u32 s14, s14, 1
    s_cbranch_scc0 L_lw11
L_lw11_d:
    s_add_u32 s10, s9, 7168
    s_add_u32 s11, s9, 13312
    s_mov_b32 s14, 262144
    s_mov_b32 exec_lo, 0x0000ffff
    s_mov_b32 exec_hi, 0x00000000
L_pp12:
    buffer_load_dword v188, v15, s[68:71], s13 offen offset:524 sc1
    buffer_load_dword v192, v15, s[68:71], s13 offen offset:780 sc1
    s_waitcnt vmcnt(0)
    v_xor_b32 v14, s57, v188
    v_xor_b32 v192, s57, v192
    v_or_b32 v14, v14, v192
    v_cmp_ne_u32 vcc, 0, v14
    s_bcnt1_i32_b64 s99, vcc
    s_cmp_le_u32 s99, 0
    s_cbranch_scc1 L_pp12_done
    s_sleep 64
    s_sub_u32 s14, s14, 1
    s_cbranch_scc0 L_pp12
L_pp12_done:
    s_mov_b64 exec, -1
    s_mov_b32 s14, 262144
L_poll13:
    buffer_load_dwordx4 v[188:191], v15, s[68:71], s13 offen offset:512 sc1
    buffer_load_dwordx4 v[192:195], v15, s[68:71], s13 offen offset:768 sc1
    buffer_load_dwordx4 v[176:179], v9, s[68:71], s10 offen sc1
    buffer_load_dwordx2 v[180:181], v9, s[68:71], s10 offen offset:16 sc1
    buffer_load_dwordx4 v[182:185], v9, s[68:71], s11 offen sc1
    buffer_load_dwordx2 v[186:187], v9, s[68:71], s11 offen offset:16 sc1
L_poll13_chk:
    s_waitcnt vmcnt(0)
    v_max_u32 v14, v176, v177
    v_max3_u32 v14, v14, v178, v179
    v_max3_u32 v14, v14, v180, v181
    v_max3_u32 v14, v14, v182, v183
    v_max3_u32 v14, v14, v184, v185
    v_max3_u32 v14, v14, v186, v187
    v_cmp_eq_u32 vcc, -1, v14
    v_xor_b32 v14, s57, v189
    v_xor_b32 v30, s57, v191
    v_or_b32 v14, v14, v30
    v_xor_b32 v30, s57, v193
    v_or_b32 v14, v14, v30
    v_xor_b32 v30, s57, v195
    v_or_b32 v14, v14, v30
    v_cmp_ne_u32 s[54:55], 0, v14
    s_nop 0
    s_or_b64 vcc, vcc, s[54:55]
    s_cbranch_scc0 L_poll13_done
    s_mov_b64 exec, vcc
    s_sleep 32
    s_sub_u32 s14, s14, 1
    s_cbranch_scc0 L_poll13
L_poll13_done:
    s_mov_b64 exec, -1
    v_lshlrev_b32 v224, 16, v176
    v_and_b32 v225, 0xffff0000, v176
    v_lshlrev_b32 v226, 16, v177
    v_and_b32 v227, 0xffff0000, v177
    v_lshlrev_b32 v228, 16, v178
    v_and_b32 v229, 0xffff0000, v178
    v_lshlrev_b32 v230, 16, v179
    v_and_b32 v231, 0xffff0000, v179
    v_lshlrev_b32 v232, 16, v180
    v_and_b32 v233, 0xffff0000, v180
    v_lshlrev_b32 v234, 16, v181
    v_and_b32 v235, 0xffff0000, v181
    v_lshlrev_b32 v236, 16, v182
    v_and_b32 v237, 0xffff0000, v182
    v_lshlrev_b32 v238, 16, v183
    v_and_b32 v239, 0xffff0000, v183
    v_lshlrev_b32 v240, 16, v184
    v_and_b32 v241, 0xffff0000, v184
    v_lshlrev_b32 v242, 16, v185
    v_and_b32 v243, 0xffff0000, v185
    v_lshlrev_b32 v244, 16, v186
    v_and_b32 v245, 0xffff0000, v186
    v_lshlrev_b32 v246, 16, v187
    v_and_b32 v247, 0xffff0000, v187
    v_max_f32 v16, v188, v192
    s_nop 1
    v_max_f32_dpp v16, v16, v16 row_ror:8 row_mask:0xf bank_mask:0xf
    s_nop 1
    v_max_f32_dpp v16, v16, v16 row_ror:4 row_mask:0xf bank_mask:0xf
    s_nop 1
    v_max_f32_dpp v16, v16, v16 row_ror:2 row_mask:0xf bank_mask:0xf
    s_nop 1
    v_max_f32_dpp v16, v16, v16 row_ror:1 row_mask:0xf bank_mask:0xf
    v_sub_f32 v17, v188, v16
    v_sub_f32 v18, v192, v16
    v_mul_f32 v17, s59, v17
    v_mul_f32 v18, s59, v18
    v_exp_f32 v17, v17
    v_exp_f32 v18, v18
    s_nop 0
    v_mul_f32 v16, v17, v190
    v_fmac_f32 v16, v18, v194
    v_mul_f32 v208, v224, v17
    v_mul_f32 v209, v225, v17
    v_mul_f32 v210, v226, v17
    v_mul_f32 v211, v227, v17
    v_mul_f32 v212, v228, v17
    v_mul_f32 v213, v229, v17
    v_mul_f32 v214, v230, v17
    v_mul_f32 v215, v231, v17
    v_mul_f32 v216, v232, v17
    v_mul_f32 v217, v233, v17
    v_mul_f32 v218, v234, v17
    v_mul_f32 v219, v235, v17
    v_fmac_f32 v208, v236, v18
    v_fmac_f32 v209, v237, v18
    v_fmac_f32 v210, v238, v18
    v_fmac_f32 v211, v239, v18
    v_fmac_f32 v212, v240, v18
    v_fmac_f32 v213, v241, v18
    v_fmac_f32 v214, v242, v18
    v_fmac_f32 v215, v243, v18
    v_fmac_f32 v216, v244, v18
    v_fmac_f32 v217, v245, v18
    v_fmac_f32 v218, v246, v18
    v_fmac_f32 v219, v247, v18
    v_add_f32_dpp v16, v16, v16 row_ror:8 row_mask:0xf bank_mask:0xf
    v_add_f32_dpp v208, v208, v208 row_ror:8 row_mask:0xf bank_mask:0xf
    v_add_f32_dpp v209, v209, v209 row_ror:8 row_mask:0xf bank_mask:0xf
    v_add_f32_dpp v210, v210, v210 row_ror:8 row_mask:0xf bank_mask:0xf
    v_add_f32_dpp v211, v211, v211 row_ror:8 row_mask:0xf bank_mask:0xf
    v_add_f32_dpp v212, v212, v212 row_ror:8 row_mask:0xf bank_mask:0xf
    v_add_f32_dpp v213, v213, v213 row_ror:8 row_mask:0xf bank_mask:0xf
    v_add_f32_dpp v214, v214, v214 row_ror:8 row_mask:0xf bank_mask:0xf
    v_add_f32_dpp v215, v215, v215 row_ror:8 row_mask:0xf bank_mask:0xf
    v_add_f32_dpp v216, v216, v216 row_ror:8 row_mask:0xf bank_mask:0xf
    v_add_f32_dpp v217, v217, v217 row_ror:8 row_mask:0xf bank_mask:0xf
    v_add_f32_dpp v218, v218, v218 row_ror:8 row_mask:0xf bank_mask:0xf
    v_add_f32_dpp v219, v219, v219 row_ror:8 row_mask:0xf bank_mask:0xf
    v_add_f32_dpp v16, v16, v16 row_ror:4 row_mask:0xf bank_mask:0xf
    v_add_f32_dpp v208, v208, v208 row_ror:4 row_mask:0xf bank_mask:0xf
    v_add_f32_dpp v209, v209, v209 row_ror:4 row_mask:0xf bank_mask:0xf
    v_add_f32_dpp v210, v210, v210 row_ror:4 row_mask:0xf bank_mask:0xf
    v_add_f32_dpp v211, v211, v211 row_ror:4 row_mask:0xf bank_mask:0xf
    v_add_f32_dpp v212, v212, v212 row_ror:4 row_mask:0xf bank_mask:0xf
    v_add_f32_dpp v213, v213, v213 row_ror:4 row_mask:0xf bank_mask:0xf
    v_add_f32_dpp v214, v214, v214 row_ror:4 row_mask:0xf bank_mask:0xf
    v_add_f32_dpp v215, v215, v215 row_ror:4 row_mask:0xf bank_mask:0xf
    v_add_f32_dpp v216, v216, v216 row_ror:4 row_mask:0xf bank_mask:0xf
    v_add_f32_dpp v217, v217, v217 row_ror:4 row_mask:0xf bank_mask:0xf
    v_add_f32_dpp v218, v218, v218 row_ror:4 row_mask:0xf bank_mask:0xf
    v_add_f32_dpp v219, v219, v219 row_ror:4 row_mask:0xf bank_mask:0xf
    v_add_f32_dpp v16, v16, v16 row_ror:2 row_mask:0xf bank_mask:0xf
    v_add_f32_dpp v208, v208, v208 row_ror:2 row_mask:0xf bank_mask:0xf
    v_add_f32_dpp v209, v209, v209 row_ror:2 row_mask:0xf bank_mask:0xf
    v_add_f32_dpp v210, v210, v210 row_ror:2 row_mask:0xf bank_mask:0xf
    v_add_f32_dpp v211, v211, v211 row_ror:2 row_mask:0xf bank_mask:0xf
    v_add_f32_dpp v212, v212, v212 row_ror:2 row_mask:0xf bank_mask:0xf
    v_add_f32_dpp v213, v213, v213 row_ror:2 row_mask:0xf bank_mask:0xf
    v_add_f32_dpp v214, v214, v214 row_ror:2 row_mask:0xf bank_mask:0xf
    v_add_f32_dpp v215, v215, v215 row_ror:2 row_mask:0xf bank_mask:0xf
    v_add_f32_dpp v216, v216, v216 row_ror:2 row_mask:0xf bank_mask:0xf
    v_add_f32_dpp v217, v217, v217 row_ror:2 row_mask:0xf bank_mask:0xf
    v_add_f32_dpp v218, v218, v218 row_ror:2 row_mask:0xf bank_mask:0xf
    v_add_f32_dpp v219, v219, v219 row_ror:2 row_mask:0xf bank_mask:0xf
    v_add_f32_dpp v16, v16, v16 row_ror:1 row_mask:0xf bank_mask:0xf
    v_add_f32_dpp v208, v208, v208 row_ror:1 row_mask:0xf bank_mask:0xf
    v_add_f32_dpp v209, v209, v209 row_ror:1 row_mask:0xf bank_mask:0xf
    v_add_f32_dpp v210, v210, v210 row_ror:1 row_mask:0xf bank_mask:0xf
    v_add_f32_dpp v211, v211, v211 row_ror:1 row_mask:0xf bank_mask:0xf
    v_add_f32_dpp v212, v212, v212 row_ror:1 row_mask:0xf bank_mask:0xf
    v_add_f32_dpp v213, v213, v213 row_ror:1 row_mask:0xf bank_mask:0xf
    v_add_f32_dpp v214, v214, v214 row_ror:1 row_mask:0xf bank_mask:0xf
    v_add_f32_dpp v215, v215, v215 row_ror:1 row_mask:0xf bank_mask:0xf
    v_add_f32_dpp v216, v216, v216 row_ror:1 row_mask:0xf bank_mask:0xf
    v_add_f32_dpp v217, v217, v217 row_ror:1 row_mask:0xf bank_mask:0xf
    v_add_f32_dpp v218, v218, v218 row_ror:1 row_mask:0xf bank_mask:0xf
    v_add_f32_dpp v219, v219, v219 row_ror:1 row_mask:0xf bank_mask:0xf
    v_rcp_f32 v16, v16
    s_mov_b32 exec_lo, 0x01000100
    s_mov_b32 exec_hi, 0x01000100
    v_mul_f32 v208, v208, v16
    v_mul_f32 v209, v209, v16
    v_mul_f32 v210, v210, v16
    v_mul_f32 v211, v211, v16
    v_mul_f32 v212, v212, v16
    v_mul_f32 v213, v213, v16
    v_mul_f32 v214, v214, v16
    v_mul_f32 v215, v215, v16
    v_mul_f32 v216, v216, v16
    v_mul_f32 v217, v217, v16
    v_mul_f32 v218, v218, v16
    v_mul_f32 v219, v219, v16
    v_cvt_pk_bf16_f32 v32, v208, v209
    v_cvt_pk_bf16_f32 v33, v210, v211
    v_cvt_pk_bf16_f32 v34, v212, v213
    v_cvt_pk_bf16_f32 v35, v214, v215
    v_cvt_pk_bf16_f32 v36, v216, v217
    v_cvt_pk_bf16_f32 v37, v218, v219
    v_min_u32 v32, -2, v32
    v_min_u32 v33, -2, v33
    v_min_u32 v34, -2, v34
    v_min_u32 v35, -2, v35
    v_min_u32 v36, -2, v36
    v_min_u32 v37, -2, v37
    buffer_store_dwordx4 v[32:35], v20, s[68:71], s13 offen sc1
    buffer_store_dwordx2 v[36:37], v20, s[68:71], s13 offen offset:16 sc1
    s_mov_b64 exec, -1
L_nog0:
    s_cmp_eq_u32 s98, 0
    s_cbranch_scc1 L_lw14_d
    v_mov_b32 v28, 0
    s_mov_b32 s14, 2097152
L_lw14:
    ds_read_b32 v29, v28 offset:16
    s_waitcnt lgkmcnt(0)
    v_cmp_eq_u32 vcc, 1, v29
    s_cbranch_vccnz L_lw14_d
    s_sleep 6
    s_sub_u32 s14, s14, 1
    s_cbranch_scc0 L_lw14
L_lw14_d:
    s_cmp_lg_u32 s82, 0
    s_cselect_b32 s10, 0, s4
    s_cmp_ge_u32 s10, 16
    s_cbranch_scc1 L_nofw
    s_cmp_eq_u32 s82, 1
    s_cbranch_scc1 L_nofw
    s_cmp_eq_u32 s98, 0
    s_cbranch_scc1 L_lw15_d
    v_mov_b32 v28, 0
    s_mov_b32 s14, 2097152
L_lw15:
    ds_read_b32 v29, v28 offset:24
    s_waitcnt lgkmcnt(0)
    v_cmp_eq_u32 vcc, 8, v29
    s_cbranch_vccnz L_lw15_d
    s_sleep 2
    s_sub_u32 s14, s14, 1
    s_cbranch_scc0 L_lw15
L_lw15_d:
L_nofw:
    s_mov_b32 s83, 0x05040100
    s_mov_b32 s84, 0x07060302
    s_cmp_eq_u32 s82, 0
    s_cbranch_scc0 L_w1
    s_mov_b32 s40, s24
    s_mov_b32 s41, s25
    s_and_b32 s42, s98, 7864320
    s_mov_b32 s43, 0x00020000
    v_mul_u32_u24 v8, 3, v3
    s_mul_i32 s10, s7, 12
    v_add_u32 v8, s10, v8
    v_and_b32 v10, 15, v1
    s_mul_i32 s8, s4, 245760
    s_lshl_b32 s10, s6, 8
    s_add_u32 s8, s8, s10
    s_add_u32 s50, s8, 10240
    s_add_u32 s51, s8, 20480
    s_add_u32 s52, s8, 30720
    v_add_u32 v11, 0, v8
    v_lshrrev_b32 v12, 3, v11
    v_and_b32 v11, 7, v11
    v_lshl_add_u32 v11, v12, 5, v11
    v_mul_u32_u24 v11, 1280, v11
    v_lshl_add_u32 v11, v10, 4, v11
    buffer_load_dwordx4 v[64:67], v11, s[40:43], s8 offen nt
    buffer_load_dwordx4 v[68:71], v11, s[40:43], s50 offen nt
    buffer_load_dwordx4 v[72:75], v11, s[40:43], s51 offen nt
    buffer_load_dwordx4 v[76:79], v11, s[40:43], s52 offen nt
    v_add_u32 v11, 1, v8
    v_lshrrev_b32 v12, 3, v11
    v_and_b32 v11, 7, v11
    v_lshl_add_u32 v11, v12, 5, v11
    v_mul_u32_u24 v11, 1280, v11
    v_lshl_add_u32 v11, v10, 4, v11
    buffer_load_dwordx4 v[80:83], v11, s[40:43], s8 offen nt
    buffer_load_dwordx4 v[84:87], v11, s[40:43], s50 offen nt
    buffer_load_dwordx4 v[88:91], v11, s[40:43], s51 offen nt
    buffer_load_dwordx4 v[92:95], v11, s[40:43], s52 offen nt
    v_add_u32 v11, 2, v8
    v_lshrrev_b32 v12, 3, v11
    v_and_b32 v11, 7, v11
    v_lshl_add_u32 v11, v12, 5, v11
    v_mul_u32_u24 v11, 1280, v11
    v_lshl_add_u32 v11, v10, 4, v11
    buffer_load_dwordx4 v[96:99], v11, s[40:43], s8 offen nt
    buffer_load_dwordx4 v[100:103], v11, s[40:43], s50 offen nt
    buffer_load_dwordx4 v[104:107], v11, s[40:43], s51 offen nt
    buffer_load_dwordx4 v[108:111], v11, s[40:43], s52 offen nt
    s_branch L_w_done
L_w1:
    s_cmp_eq_u32 s82, 1
    s_cbranch_scc0 L_w2
    s_mov_b32 s40, s28
    s_mov_b32 s41, s29
    s_and_b32 s42, s98, 1966080
    s_mov_b32 s43, 0x00020000
    s_mov_b32 s44, s30
    s_mov_b32 s45, s31
    s_and_b32 s46, s98, 1966080
    s_mov_b32 s47, 0x00020000
    v_mul_u32_u24 v8, 24576, v3
    v_and_b32 v9, 15, v1
    v_lshl_add_u32 v8, v9, 2, v8
    s_mul_i32 s8, s7, 491520
    s_lshl_b32 s9, s85, 6
    s_add_u32 s8, s8, s9
    s_mov_b32 s9, s8
    s_waitcnt vmcnt(0)
    buffer_load_dword v72, v8, s[40:43], s8 offen nt
    s_add_u32 s8, s8, 3072
    buffer_load_dword v73, v8, s[40:43], s8 offen nt
    s_add_u32 s8, s8, 3072
    buffer_load_dword v74, v8, s[40:43], s8 offen nt
    s_add_u32 s8, s8, 3072
    buffer_load_dword v75, v8, s[40:43], s8 offen nt
    s_add_u32 s8, s8, 3072
    buffer_load_dword v76, v8, s[40:43], s8 offen nt
    s_add_u32 s8, s8, 3072
    buffer_load_dword v77, v8, s[40:43], s8 offen nt
    s_add_u32 s8, s8, 3072
    buffer_load_dword v78, v8, s[40:43], s8 offen nt
    s_add_u32 s8, s8, 3072
    buffer_load_dword v79, v8, s[40:43], s8 offen nt
    s_add_u32 s8, s8, 76800
    buffer_load_dword v80, v8, s[40:43], s8 offen nt
    s_add_u32 s8, s8, 3072
    buffer_load_dword v81, v8, s[40:43], s8 offen nt
    s_add_u32 s8, s8, 3072
    buffer_load_dword v82, v8, s[40:43], s8 offen nt
    s_add_u32 s8, s8, 3072
    buffer_load_dword v83, v8, s[40:43], s8 offen nt
    s_add_u32 s8, s8, 3072
    buffer_load_dword v84, v8, s[40:43], s8 offen nt
    s_add_u32 s8, s8, 3072
    buffer_load_dword v85, v8, s[40:43], s8 offen nt
    s_add_u32 s8, s8, 3072
    buffer_load_dword v86, v8, s[40:43], s8 offen nt
    s_add_u32 s8, s8, 3072
    buffer_load_dword v87, v8, s[40:43], s8 offen nt
    s_add_u32 s8, s8, 76800
    buffer_load_dword v88, v8, s[40:43], s8 offen nt
    s_add_u32 s8, s8, 3072
    buffer_load_dword v89, v8, s[40:43], s8 offen nt
    s_add_u32 s8, s8, 3072
    buffer_load_dword v90, v8, s[40:43], s8 offen nt
    s_add_u32 s8, s8, 3072
    buffer_load_dword v91, v8, s[40:43], s8 offen nt
    s_add_u32 s8, s8, 3072
    buffer_load_dword v92, v8, s[40:43], s8 offen nt
    s_add_u32 s8, s8, 3072
    buffer_load_dword v93, v8, s[40:43], s8 offen nt
    s_add_u32 s8, s8, 3072
    buffer_load_dword v94, v8, s[40:43], s8 offen nt
    s_add_u32 s8, s8, 3072
    buffer_load_dword v95, v8, s[40:43], s8 offen nt
    s_add_u32 s8, s8, 76800
    buffer_load_dword v96, v8, s[40:43], s8 offen nt
    s_add_u32 s8, s8, 3072
    buffer_load_dword v97, v8, s[40:43], s8 offen nt
    s_add_u32 s8, s8, 3072
    buffer_load_dword v98, v8, s[40:43], s8 offen nt
    s_add_u32 s8, s8, 3072
    buffer_load_dword v99, v8, s[40:43], s8 offen nt
    s_add_u32 s8, s8, 3072
    buffer_load_dword v100, v8, s[40:43], s8 offen nt
    s_add_u32 s8, s8, 3072
    buffer_load_dword v101, v8, s[40:43], s8 offen nt
    s_add_u32 s8, s8, 3072
    buffer_load_dword v102, v8, s[40:43], s8 offen nt
    s_add_u32 s8, s8, 3072
    buffer_load_dword v103, v8, s[40:43], s8 offen nt
    s_add_u32 s8, s8, 76800
    buffer_load_dword v104, v8, s[40:43], s8 offen nt
    s_add_u32 s8, s8, 3072
    buffer_load_dword v105, v8, s[40:43], s8 offen nt
    s_add_u32 s8, s8, 3072
    buffer_load_dword v106, v8, s[40:43], s8 offen nt
    s_add_u32 s8, s8, 3072
    buffer_load_dword v107, v8, s[40:43], s8 offen nt
    s_add_u32 s8, s8, 3072
    buffer_load_dword v108, v8, s[40:43], s8 offen nt
    s_add_u32 s8, s8, 3072
    buffer_load_dword v109, v8, s[40:43], s8 offen nt
    s_add_u32 s8, s8, 3072
    buffer_load_dword v110, v8, s[40:43], s8 offen nt
    s_add_u32 s8, s8, 3072
    buffer_load_dword v111, v8, s[40:43], s8 offen nt
    s_add_u32 s8, s8, 76800
    buffer_load_dword v112, v8, s[44:47], s9 offen nt
    s_add_u32 s9, s9, 3072
    buffer_load_dword v113, v8, s[44:47], s9 offen nt
    s_add_u32 s9, s9, 3072
    buffer_load_dword v114, v8, s[44:47], s9 offen nt
    s_add_u32 s9, s9, 3072
    buffer_load_dword v115, v8, s[44:47], s9 offen nt
    s_add_u32 s9, s9, 3072
    buffer_load_dword v116, v8, s[44:47], s9 offen nt
    s_add_u32 s9, s9, 3072
    buffer_load_dword v117, v8, s[44:47], s9 offen nt
    s_add_u32 s9, s9, 3072
    buffer_load_dword v118, v8, s[44:47], s9 offen nt
    s_add_u32 s9, s9, 3072
    buffer_load_dword v119, v8, s[44:47], s9 offen nt
    s_add_u32 s9, s9, 76800
    buffer_load_dword v120, v8, s[44:47], s9 offen nt
    s_add_u32 s9, s9, 3072
    buffer_load_dword v121, v8, s[44:47], s9 offen nt
    s_add_u32 s9, s9, 3072
    buffer_load_dword v122, v8, s[44:47], s9 offen nt
    s_add_u32 s9, s9, 3072
    buffer_load_dword v123, v8, s[44:47], s9 offen nt
    s_add_u32 s9, s9, 3072
    buffer_load_dword v124, v8, s[44:47], s9 offen nt
    s_add_u32 s9, s9, 3072
    buffer_load_dword v125, v8, s[44:47], s9 offen nt
    s_add_u32 s9, s9, 3072
    buffer_load_dword v126, v8, s[44:47], s9 offen nt
    s_add_u32 s9, s9, 3072
    buffer_load_dword v127, v8, s[44:47], s9 offen nt
    s_add_u32 s9, s9, 76800
    s_waitcnt vmcnt(48)
    v_perm_b32 v64, v73, v72, s83
    v_perm_b32 v68, v73, v72, s84
    v_perm_b32 v65, v75, v74, s83
    v_perm_b32 v69, v75, v74, s84
    v_perm_b32 v66, v77, v76, s83
    v_perm_b32 v70, v77, v76, s84
    v_perm_b32 v67, v79, v78, s83
    v_perm_b32 v71, v79, v78, s84
    buffer_load_dword v128, v8, s[44:47], s9 offen nt
    s_add_u32 s9, s9, 3072
    buffer_load_dword v129, v8, s[44:47], s9 offen nt
    s_add_u32 s9, s9, 3072
    buffer_load_dword v130, v8, s[44:47], s9 offen nt
    s_add_u32 s9, s9, 3072
    buffer_load_dword v131, v8, s[44:47], s9 offen nt
    s_add_u32 s9, s9, 3072
    buffer_load_dword v132, v8, s[44:47], s9 offen nt
    s_add_u32 s9, s9, 3072
    buffer_load_dword v133, v8, s[44:47], s9 offen nt
    s_add_u32 s9, s9, 3072
    buffer_load_dword v134, v8, s[44:47], s9 offen nt
    s_add_u32 s9, s9, 3072
    buffer_load_dword v135, v8, s[44:47], s9 offen nt
    s_add_u32 s9, s9, 76800
    s_waitcnt vmcnt(48)
    v_perm_b32 v72, v81, v80, s83
    v_perm_b32 v76, v81, v80, s84
    v_perm_b32 v73, v83, v82, s83
    v_perm_b32 v77, v83, v82, s84
    v_perm_b32 v74, v85, v84, s83
    v_perm_b32 v78, v85, v84, s84
    v_perm_b32 v75, v87, v86, s83
    v_perm_b32 v79, v87, v86, s84
    buffer_load_dword v136, v8, s[44:47], s9 offen nt
    s_add_u32 s9, s9, 3072
    buffer_load_dword v137, v8, s[44:47], s9 offen nt
    s_add_u32 s9, s9, 3072
    buffer_load_dword v138, v8, s[44:47], s9 offen nt
    s_add_u32 s9, s9, 3072
    buffer_load_dword v139, v8, s[44:47], s9 offen nt
    s_add_u32 s9, s9, 3072
    buffer_load_dword v140, v8, s[44:47], s9 offen nt
    s_add_u32 s9, s9, 3072
    buffer_load_dword v141, v8, s[44:47], s9 offen nt
    s_add_u32 s9, s9, 3072
    buffer_load_dword v142, v8, s[44:47], s9 offen nt
    s_add_u32 s9, s9, 3072
    buffer_load_dword v143, v8, s[44:47], s9 offen nt
    s_add_u32 s9, s9, 76800
    s_waitcnt vmcnt(48)
    v_perm_b32 v80, v89, v88, s83
    v_perm_b32 v84, v89, v88, s84
    v_perm_b32 v81, v91, v90, s83
    v_perm_b32 v85, v91, v90, s84
    v_perm_b32 v82, v93, v92, s83
    v_perm_b32 v86, v93, v92, s84
    v_perm_b32 v83, v95, v94, s83
    v_perm_b32 v87, v95, v94, s84
    buffer_load_dword v144, v8, s[44:47], s9 offen nt
    s_add_u32 s9, s9, 3072
    buffer_load_dword v145, v8, s[44:47], s9 offen nt
    s_add_u32 s9, s9, 3072
    buffer_load_dword v146, v8, s[44:47], s9 offen nt
    s_add_u32 s9, s9, 3072
    buffer_load_dword v147, v8, s[44:47], s9 offen nt
    s_add_u32 s9, s9, 3072
    buffer_load_dword v148, v8, s[44:47], s9 offen nt
    s_add_u32 s9, s9, 3072
    buffer_load_dword v149, v8, s[44:47], s9 offen nt
    s_add_u32 s9, s9, 3072
    buffer_load_dword v150, v8, s[44:47], s9 offen nt
    s_add_u32 s9, s9, 3072
    buffer_load_dword v151, v8, s[44:47], s9 offen nt
    s_add_u32 s9, s9, 76800
    s_waitcnt vmcnt(48)
    v_perm_b32 v88, v97, v96, s83
    v_perm_b32 v92, v97, v96, s84
    v_perm_b32 v89, v99, v98, s83
    v_perm_b32 v93, v99, v98, s84
    v_perm_b32 v90, v101, v100, s83
    v_perm_b32 v94, v101, v100, s84
    v_perm_b32 v91, v103, v102, s83
    v_perm_b32 v95, v103, v102, s84
    s_waitcnt vmcnt(40)
    v_perm_b32 v96, v105, v104, s83
    v_perm_b32 v100, v105, v104, s84
    v_perm_b32 v97, v107, v106, s83
    v_perm_b32 v101, v107, v106, s84
    v_perm_b32 v98, v109, v108, s83
    v_perm_b32 v102, v109, v108, s84
    v_perm_b32 v99, v111, v110, s83
    v_perm_b32 v103, v111, v110, s84
    s_waitcnt vmcnt(32)
    v_perm_b32 v104, v113, v112, s83
    v_perm_b32 v108, v113, v112, s84
    v_perm_b32 v105, v115, v114, s83
    v_perm_b32 v109, v115, v114, s84
    v_perm_b32 v106, v117, v116, s83
    v_perm_b32 v110, v117, v116, s84
    v_perm_b32 v107, v119, v118, s83
    v_perm_b32 v111, v119, v118, s84
    s_waitcnt vmcnt(24)
    v_perm_b32 v112, v121, v120, s83
    v_perm_b32 v116, v121, v120, s84
    v_perm_b32 v113, v123, v122, s83
    v_perm_b32 v117, v123, v122, s84
    v_perm_b32 v114, v125, v124, s83
    v_perm_b32 v118, v125, v124, s84
    v_perm_b32 v115, v127, v126, s83
    v_perm_b32 v119, v127, v126, s84
    s_waitcnt vmcnt(16)
    v_perm_b32 v120, v129, v128, s83
    v_perm_b32 v124, v129, v128, s84
    v_perm_b32 v121, v131, v130, s83
    v_perm_b32 v125, v131, v130, s84
    v_perm_b32 v122, v133, v132, s83
    v_perm_b32 v126, v133, v132, s84
    v_perm_b32 v123, v135, v134, s83
    v_perm_b32 v127, v135, v134, s84
    s_waitcnt vmcnt(8)
    v_perm_b32 v128, v137, v136, s83
    v_perm_b32 v132, v137, v136, s84
    v_perm_b32 v129, v139, v138, s83
    v_perm_b32 v133, v139, v138, s84
    v_perm_b32 v130, v141, v140, s83
    v_perm_b32 v134, v141, v140, s84
    v_perm_b32 v131, v143, v142, s83
    v_perm_b32 v135, v143, v142, s84
    s_waitcnt vmcnt(0)
    v_perm_b32 v136, v145, v144, s83
    v_perm_b32 v140, v145, v144, s84
    v_perm_b32 v137, v147, v146, s83
    v_perm_b32 v141, v147, v146, s84
    v_perm_b32 v138, v149, v148, s83
    v_perm_b32 v142, v149, v148, s84
    v_perm_b32 v139, v151, v150, s83
    v_perm_b32 v143, v151, v150, s84
    s_branch L_w_done
L_w2:
    s_cmp_eq_u32 s82, 2
    s_cbranch_scc0 L_w_done
    s_mov_b32 s40, s32
    s_mov_b32 s41, s33
    s_and_b32 s42, s98, 1966080
    s_mov_b32 s43, 0x00020000
    v_mul_u32_u24 v8, 10240, v3
    v_and_b32 v9, 15, v1
    v_lshl_add_u32 v8, v9, 2, v8
    s_mul_i32 s8, s7, 491520
    s_lshl_b32 s9, s85, 6
    s_add_u32 s8, s8, s9
    s_waitcnt vmcnt(0)
    buffer_load_dword v72, v8, s[40:43], s8 offen nt
    s_add_u32 s8, s8, 1280
    buffer_load_dword v73, v8, s[40:43], s8 offen nt
    s_add_u32 s8, s8, 1280
    buffer_load_dword v74, v8, s[40:43], s8 offen nt
    s_add_u32 s8, s8, 1280
    buffer_load_dword v75, v8, s[40:43], s8 offen nt
    s_add_u32 s8, s8, 1280
    buffer_load_dword v76, v8, s[40:43], s8 offen nt
    s_add_u32 s8, s8, 1280
    buffer_load_dword v77, v8, s[40:43], s8 offen nt
    s_add_u32 s8, s8, 1280
    buffer_load_dword v78, v8, s[40:43], s8 offen nt
    s_add_u32 s8, s8, 1280
    buffer_load_dword v79, v8, s[40:43], s8 offen nt
    s_add_u32 s8, s8, 32000
    buffer_load_dword v80, v8, s[40:43], s8 offen nt
    s_add_u32 s8, s8, 1280
    buffer_load_dword v81, v8, s[40:43], s8 offen nt
    s_add_u32 s8, s8, 1280
    buffer_load_dword v82, v8, s[40:43], s8 offen nt
    s_add_u32 s8, s8, 1280
    buffer_load_dword v83, v8, s[40:43], s8 offen nt
    s_add_u32 s8, s8, 1280
    buffer_load_dword v84, v8, s[40:43], s8 offen nt
    s_add_u32 s8, s8, 1280
    buffer_load_dword v85, v8, s[40:43], s8 offen nt
    s_add_u32 s8, s8, 1280
    buffer_load_dword v86, v8, s[40:43], s8 offen nt
    s_add_u32 s8, s8, 1280
    buffer_load_dword v87, v8, s[40:43], s8 offen nt
    s_add_u32 s8, s8, 32000
    buffer_load_dword v88, v8, s[40:43], s8 offen nt
    s_add_u32 s8, s8, 1280
    buffer_load_dword v89, v8, s[40:43], s8 offen nt
    s_add_u32 s8, s8, 1280
    buffer_load_dword v90, v8, s[40:43], s8 offen nt
    s_add_u32 s8, s8, 1280
    buffer_load_dword v91, v8, s[40:43], s8 offen nt
    s_add_u32 s8, s8, 1280
    buffer_load_dword v92, v8, s[40:43], s8 offen nt
    s_add_u32 s8, s8, 1280
    buffer_load_dword v93, v8, s[40:43], s8 offen nt
    s_add_u32 s8, s8, 1280
    buffer_load_dword v94, v8, s[40:43], s8 offen nt
    s_add_u32 s8, s8, 1280
    buffer_load_dword v95, v8, s[40:43], s8 offen nt
    s_add_u32 s8, s8, 32000
    buffer_load_dword v96, v8, s[40:43], s8 offen nt
    s_add_u32 s8, s8, 1280
    buffer_load_dword v97, v8, s[40:43], s8 offen nt
    s_add_u32 s8, s8, 1280
    buffer_load_dword v98, v8, s[40:43], s8 offen nt
    s_add_u32 s8, s8, 1280
    buffer_load_dword v99, v8, s[40:43], s8 offen nt
    s_add_u32 s8, s8, 1280
    buffer_load_dword v100, v8, s[40:43], s8 offen nt
    s_add_u32 s8, s8, 1280
    buffer_load_dword v101, v8, s[40:43], s8 offen nt
    s_add_u32 s8, s8, 1280
    buffer_load_dword v102, v8, s[40:43], s8 offen nt
    s_add_u32 s8, s8, 1280
    buffer_load_dword v103, v8, s[40:43], s8 offen nt
    s_add_u32 s8, s8, 32000
    buffer_load_dword v104, v8, s[40:43], s8 offen nt
    s_add_u32 s8, s8, 1280
    buffer_load_dword v105, v8, s[40:43], s8 offen nt
    s_add_u32 s8, s8, 1280
    buffer_load_dword v106, v8, s[40:43], s8 offen nt
    s_add_u32 s8, s8, 1280
    buffer_load_dword v107, v8, s[40:43], s8 offen nt
    s_add_u32 s8, s8, 1280
    buffer_load_dword v108, v8, s[40:43], s8 offen nt
    s_add_u32 s8, s8, 1280
    buffer_load_dword v109, v8, s[40:43], s8 offen nt
    s_add_u32 s8, s8, 1280
    buffer_load_dword v110, v8, s[40:43], s8 offen nt
    s_add_u32 s8, s8, 1280
    buffer_load_dword v111, v8, s[40:43], s8 offen nt
    s_add_u32 s8, s8, 32000
    buffer_load_dword v112, v8, s[40:43], s8 offen nt
    s_add_u32 s8, s8, 1280
    buffer_load_dword v113, v8, s[40:43], s8 offen nt
    s_add_u32 s8, s8, 1280
    buffer_load_dword v114, v8, s[40:43], s8 offen nt
    s_add_u32 s8, s8, 1280
    buffer_load_dword v115, v8, s[40:43], s8 offen nt
    s_add_u32 s8, s8, 1280
    buffer_load_dword v116, v8, s[40:43], s8 offen nt
    s_add_u32 s8, s8, 1280
    buffer_load_dword v117, v8, s[40:43], s8 offen nt
    s_add_u32 s8, s8, 1280
    buffer_load_dword v118, v8, s[40:43], s8 offen nt
    s_add_u32 s8, s8, 1280
    buffer_load_dword v119, v8, s[40:43], s8 offen nt
    s_add_u32 s8, s8, 32000
    buffer_load_dword v120, v8, s[40:43], s8 offen nt
    s_add_u32 s8, s8, 1280
    buffer_load_dword v121, v8, s[40:43], s8 offen nt
    s_add_u32 s8, s8, 1280
    buffer_load_dword v122, v8, s[40:43], s8 offen nt
    s_add_u32 s8, s8, 1280
    buffer_load_dword v123, v8, s[40:43], s8 offen nt
    s_add_u32 s8, s8, 1280
    buffer_load_dword v124, v8, s[40:43], s8 offen nt
    s_add_u32 s8, s8, 1280
    buffer_load_dword v125, v8, s[40:43], s8 offen nt
    s_add_u32 s8, s8, 1280
    buffer_load_dword v126, v8, s[40:43], s8 offen nt
    s_add_u32 s8, s8, 1280
    buffer_load_dword v127, v8, s[40:43], s8 offen nt
    s_add_u32 s8, s8, 32000
    s_waitcnt vmcnt(48)
    v_perm_b32 v64, v73, v72, s83
    v_perm_b32 v68, v73, v72, s84
    v_perm_b32 v65, v75, v74, s83
    v_perm_b32 v69, v75, v74, s84
    v_perm_b32 v66, v77, v76, s83
    v_perm_b32 v70, v77, v76, s84
    v_perm_b32 v67, v79, v78, s83
    v_perm_b32 v71, v79, v78, s84
    buffer_load_dword v128, v8, s[40:43], s8 offen nt
    s_add_u32 s8, s8, 1280
    buffer_load_dword v129, v8, s[40:43], s8 offen nt
    s_add_u32 s8, s8, 1280
    buffer_load_dword v130, v8, s[40:43], s8 offen nt
    s_add_u32 s8, s8, 1280
    buffer_load_dword v131, v8, s[40:43], s8 offen nt
    s_add_u32 s8, s8, 1280
    buffer_load_dword v132, v8, s[40:43], s8 offen nt
    s_add_u32 s8, s8, 1280
    buffer_load_dword v133, v8, s[40:43], s8 offen nt
    s_add_u32 s8, s8, 1280
    buffer_load_dword v134, v8, s[40:43], s8 offen nt
    s_add_u32 s8, s8, 1280
    buffer_load_dword v135, v8, s[40:43], s8 offen nt
    s_add_u32 s8, s8, 32000
    s_waitcnt vmcnt(48)
    v_perm_b32 v72, v81, v80, s83
    v_perm_b32 v76, v81, v80, s84
    v_perm_b32 v73, v83, v82, s83
    v_perm_b32 v77, v83, v82, s84
    v_perm_b32 v74, v85, v84, s83
    v_perm_b32 v78, v85, v84, s84
    v_perm_b32 v75, v87, v86, s83
    v_perm_b32 v79, v87, v86, s84
    buffer_load_dword v136, v8, s[40:43], s8 offen nt
    s_add_u32 s8, s8, 1280
    buffer_load_dword v137, v8, s[40:43], s8 offen nt
    s_add_u32 s8, s8, 1280
    buffer_load_dword v138, v8, s[40:43], s8 offen nt
    s_add_u32 s8, s8, 1280
    buffer_load_dword v139, v8, s[40:43], s8 offen nt
    s_add_u32 s8, s8, 1280
    buffer_load_dword v140, v8, s[40:43], s8 offen nt
    s_add_u32 s8, s8, 1280
    buffer_load_dword v141, v8, s[40:43], s8 offen nt
    s_add_u32 s8, s8, 1280
    buffer_load_dword v142, v8, s[40:43], s8 offen nt
    s_add_u32 s8, s8, 1280
    buffer_load_dword v143, v8, s[40:43], s8 offen nt
    s_add_u32 s8, s8, 32000
    s_waitcnt vmcnt(48)
    v_perm_b32 v80, v89, v88, s83
    v_perm_b32 v84, v89, v88, s84
    v_perm_b32 v81, v91, v90, s83
    v_perm_b32 v85, v91, v90, s84
    v_perm_b32 v82, v93, v92, s83
    v_perm_b32 v86, v93, v92, s84
    v_perm_b32 v83, v95, v94, s83
    v_perm_b32 v87, v95, v94, s84
    buffer_load_dword v144, v8, s[40:43], s8 offen nt
    s_add_u32 s8, s8, 1280
    buffer_load_dword v145, v8, s[40:43], s8 offen nt
    s_add_u32 s8, s8, 1280
    buffer_load_dword v146, v8, s[40:43], s8 offen nt
    s_add_u32 s8, s8, 1280
    buffer_load_dword v147, v8, s[40:43], s8 offen nt
    s_add_u32 s8, s8, 1280
    buffer_load_dword v148, v8, s[40:43], s8 offen nt
    s_add_u32 s8, s8, 1280
    buffer_load_dword v149, v8, s[40:43], s8 offen nt
    s_add_u32 s8, s8, 1280
    buffer_load_dword v150, v8, s[40:43], s8 offen nt
    s_add_u32 s8, s8, 1280
    buffer_load_dword v151, v8, s[40:43], s8 offen nt
    s_add_u32 s8, s8, 32000
    s_waitcnt vmcnt(48)
    v_perm_b32 v88, v97, v96, s83
    v_perm_b32 v92, v97, v96, s84
    v_perm_b32 v89, v99, v98, s83
    v_perm_b32 v93, v99, v98, s84
    v_perm_b32 v90, v101, v100, s83
    v_perm_b32 v94, v101, v100, s84
    v_perm_b32 v91, v103, v102, s83
    v_perm_b32 v95, v103, v102, s84
    buffer_load_dword v152, v8, s[40:43], s8 offen nt
    s_add_u32 s8, s8, 1280
    buffer_load_dword v153, v8, s[40:43], s8 offen nt
    s_add_u32 s8, s8, 1280
    buffer_load_dword v154, v8, s[40:43], s8 offen nt
    s_add_u32 s8, s8, 1280
    buffer_load_dword v155, v8, s[40:43], s8 offen nt
    s_add_u32 s8, s8, 1280
    buffer_load_dword v156, v8, s[40:43], s8 offen nt
    s_add_u32 s8, s8, 1280
    buffer_load_dword v157, v8, s[40:43], s8 offen nt
    s_add_u32 s8, s8, 1280
    buffer_load_dword v158, v8, s[40:43], s8 offen nt
    s_add_u32 s8, s8, 1280
    buffer_load_dword v159, v8, s[40:43], s8 offen nt
    s_add_u32 s8, s8, 32000
    s_waitcnt vmcnt(48)
    v_perm_b32 v96, v105, v104, s83
    v_perm_b32 v100, v105, v104, s84
    v_perm_b32 v97, v107, v106, s83
    v_perm_b32 v101, v107, v106, s84
    v_perm_b32 v98, v109, v108, s83
    v_perm_b32 v102, v109, v108, s84
    v_perm_b32 v99, v111, v110, s83
    v_perm_b32 v103, v111, v110, s84
    buffer_load_dword v160, v8, s[40:43], s8 offen nt
    s_add_u32 s8, s8, 1280
    buffer_load_dword v161, v8, s[40:43], s8 offen nt
    s_add_u32 s8, s8, 1280
    buffer_load_dword v162, v8, s[40:43], s8 offen nt
    s_add_u32 s8, s8, 1280
    buffer_load_dword v163, v8, s[40:43], s8 offen nt
    s_add_u32 s8, s8, 1280
    buffer_load_dword v164, v8, s[40:43], s8 offen nt
    s_add_u32 s8, s8, 1280
    buffer_load_dword v165, v8, s[40:43], s8 offen nt
    s_add_u32 s8, s8, 1280
    buffer_load_dword v166, v8, s[40:43], s8 offen nt
    s_add_u32 s8, s8, 1280
    buffer_load_dword v167, v8, s[40:43], s8 offen nt
    s_add_u32 s8, s8, 32000
    s_waitcnt vmcnt(48)
    v_perm_b32 v104, v113, v112, s83
    v_perm_b32 v108, v113, v112, s84
    v_perm_b32 v105, v115, v114, s83
    v_perm_b32 v109, v115, v114, s84
    v_perm_b32 v106, v117, v116, s83
    v_perm_b32 v110, v117, v116, s84
    v_perm_b32 v107, v119, v118, s83
    v_perm_b32 v111, v119, v118, s84
    s_waitcnt vmcnt(40)
    v_perm_b32 v112, v121, v120, s83
    v_perm_b32 v116, v121, v120, s84
    v_perm_b32 v113, v123, v122, s83
    v_perm_b32 v117, v123, v122, s84
    v_perm_b32 v114, v125, v124, s83
    v_perm_b32 v118, v125, v124, s84
    v_perm_b32 v115, v127, v126, s83
    v_perm_b32 v119, v127, v126, s84
    s_waitcnt vmcnt(32)
    v_perm_b32 v120, v129, v128, s83
    v_perm_b32 v124, v129, v128, s84
    v_perm_b32 v121, v131, v130, s83
    v_perm_b32 v125, v131, v130, s84
    v_perm_b32 v122, v133, v132, s83
    v_perm_b32 v126, v133, v132, s84
    v_perm_b32 v123, v135, v134, s83
    v_perm_b32 v127, v135, v134, s84
    s_waitcnt vmcnt(24)
    v_perm_b32 v128, v137, v136, s83
    v_perm_b32 v132, v137, v136, s84
    v_perm_b32 v129, v139, v138, s83
    v_perm_b32 v133, v139, v138, s84
    v_perm_b32 v130, v141, v140, s83
    v_perm_b32 v134, v141, v140, s84
    v_perm_b32 v131, v143, v142, s83
    v_perm_b32 v135, v143, v142, s84
    s_waitcnt vmcnt(16)
    v_perm_b32 v136, v145, v144, s83
    v_perm_b32 v140, v145, v144, s84
    v_perm_b32 v137, v147, v146, s83
    v_perm_b32 v141, v147, v146, s84
    v_perm_b32 v138, v149, v148, s83
    v_perm_b32 v142, v149, v148, s84
    v_perm_b32 v139, v151, v150, s83
    v_perm_b32 v143, v151, v150, s84
    s_waitcnt vmcnt(8)
    v_perm_b32 v144, v153, v152, s83
    v_perm_b32 v148, v153, v152, s84
    v_perm_b32 v145, v155, v154, s83
    v_perm_b32 v149, v155, v154, s84
    v_perm_b32 v146, v157, v156, s83
    v_perm_b32 v150, v157, v156, s84
    v_perm_b32 v147, v159, v158, s83
    v_perm_b32 v151, v159, v158, s84
    s_waitcnt vmcnt(0)
    v_perm_b32 v152, v161, v160, s83
    v_perm_b32 v156, v161, v160, s84
    v_perm_b32 v153, v163, v162, s83
    v_perm_b32 v157, v163, v162, s84
    v_perm_b32 v154, v165, v164, s83
    v_perm_b32 v158, v165, v164, s84
    v_perm_b32 v155, v167, v166, s83
    v_perm_b32 v159, v167, v166, s84
L_w_done:
    s_cmp_eq_u32 s82, 1
    s_cbranch_scc1 L_ffn1
    s_cmp_eq_u32 s82, 2
    s_cbranch_scc1 L_ffn2
    s_cmp_eq_u32 s82, 4
    s_cbranch_scc1 L_red
L_wo:
    s_lshl_b32 s10, s7, 6
    v_add_u32 v10, s10, v1
    v_and_b32 v11, 7, v10
    v_lshlrev_b32 v11, 4, v11
    v_bfe_u32 v12, v10, 3, 2
    v_lshl_add_u32 v11, v12, 2, v11
    v_bfe_u32 v12, v10, 5, 2
    v_lshl_add_u32 v11, v12, 8, v11
    v_lshrrev_b32 v12, 7, v10
    v_lshl_add_u32 v11, v12, 7, v11
    v_mul_u32_u24 v12, 2560, v12
    v_and_b32 v13, 127, v10
    v_lshl_add_u32 v12, v13, 2, v12
    s_mul_i32 s12, s4, 35840
    s_lshl_b32 s11, s6, 9
    s_add_u32 s12, s12, s11
    s_add_u32 s12, s12, 3146752
    s_lshl_b32 s11, s7, 10
    v_add_u32 v13, s11, v2
    s_cmp_lt_u32 s4, 16
    s_cselect_b32 exec_lo, -1, 0x00ff00ff
    s_mov_b32 exec_hi, exec_lo
    s_mov_b32 s14, 262144
L_poll16:
    buffer_load_dwordx4 v[176:179], v20, s[68:71], s13 offen sc1
    buffer_load_dwordx2 v[180:181], v20, s[68:71], s13 offen offset:16 sc1
L_poll16_chk:
    s_waitcnt vmcnt(0)
    v_max_u32 v14, v176, v177
    v_max3_u32 v14, v14, v178, v179
    v_max3_u32 v14, v14, v180, v181
    v_cmp_eq_u32 vcc, -1, v14
    s_cbranch_vccz L_poll16_done
    s_mov_b64 exec, vcc
    s_sleep 4
    s_sub_u32 s14, s14, 1
    s_cbranch_scc0 L_poll16
L_poll16_done:
    s_mov_b64 exec, -1
    s_mov_b32 s10, 0x01000100
    s_mov_b32 s11, 0x03020302
    v_perm_b32 v32, v176, v176, s10
    v_perm_b32 v33, v176, v176, s11
    v_perm_b32 v34, v177, v177, s10
    v_perm_b32 v35, v177, v177, s11
    v_perm_b32 v36, v178, v178, s10
    v_perm_b32 v37, v178, v178, s11
    v_perm_b32 v38, v179, v179, s10
    v_perm_b32 v39, v179, v179, s11
    v_perm_b32 v40, v180, v180, s10
    v_perm_b32 v41, v180, v180, s11
    v_perm_b32 v42, v181, v181, s10
    v_perm_b32 v43, v181, v181, s11
    s_cmp_lt_u32 s4, 16
    s_cbranch_scc1 L_nog1
    s_lshr_b32 s10, s4, 3
    s_lshl_b32 s10, s10, 2
    s_cmp_eq_u32 s98, 0
    s_cbranch_scc1 L_lw17_d
    v_mov_b32 v28, s10
    s_mov_b32 s14, 2097152
L_lw17:
    ds_read_b32 v29, v28 offset:80
    s_waitcnt lgkmcnt(0)
    v_cmp_eq_u32 vcc, 4, v29
    s_cbranch_vccnz L_lw17_d
    s_sleep 1
    s_sub_u32 s14, s14, 1
    s_cbranch_scc0 L_lw17
L_lw17_d:
    v_and_b32 v21, 15, v1
    v_lshlrev_b32 v21, 9, v21
    v_mul_u32_u24 v22, 24, v3
    v_add_u32 v22, v21, v22
    s_lshl_b32 s10, s7, 7
    s_add_u32 s10, s10, s13
    s_add_u32 s10, s10, 7168
    s_add_u32 s11, s10, 8192
    s_mov_b32 s14, 262144
L_poll18:
    buffer_load_dwordx4 v[176:179], v22, s[68:71], s10 offen sc1
    buffer_load_dwordx2 v[180:181], v22, s[68:71], s10 offen offset:16 sc1
    buffer_load_dwordx2 v[188:189], v21, s[68:71], s10 offen offset:96 sc1
    buffer_load_dwordx4 v[182:185], v22, s[68:71], s11 offen sc1
    buffer_load_dwordx2 v[186:187], v22, s[68:71], s11 offen offset:16 sc1
    buffer_load_dwordx2 v[192:193], v21, s[68:71], s11 offen offset:96 sc1
L_poll18_chk:
    s_waitcnt vmcnt(0)
    v_max_u32 v14, v176, v177
    v_max3_u32 v14, v14, v178, v179
    v_max3_u32 v14, v14, v180, v181
    v_max3_u32 v14, v14, v182, v183
    v_max3_u32 v14, v14, v184, v185
    v_max3_u32 v14, v14, v186, v187
    v_max3_u32 v14, v14, v188, v189
    v_max3_u32 v14, v14, v192, v193
    v_cmp_eq_u32 vcc, -1, v14
    s_cbranch_vccz L_poll18_done
    s_mov_b64 exec, vcc
    s_sleep 1
    s_sub_u32 s14, s14, 1
    s_cbranch_scc0 L_poll18
L_poll18_done:
    s_mov_b64 exec, -1
    v_lshlrev_b32 v224, 16, v176
    v_and_b32 v225, 0xffff0000, v176
    v_lshlrev_b32 v226, 16, v177
    v_and_b32 v227, 0xffff0000, v177
    v_lshlrev_b32 v228, 16, v178
    v_and_b32 v229, 0xffff0000, v178
    v_lshlrev_b32 v230, 16, v179
    v_and_b32 v231, 0xffff0000, v179
    v_lshlrev_b32 v232, 16, v180
    v_and_b32 v233, 0xffff0000, v180
    v_lshlrev_b32 v234, 16, v181
    v_and_b32 v235, 0xffff0000, v181
    v_lshlrev_b32 v236, 16, v182
    v_and_b32 v237, 0xffff0000, v182
    v_lshlrev_b32 v238, 16, v183
    v_and_b32 v239, 0xffff0000, v183
    v_lshlrev_b32 v240, 16, v184
    v_and_b32 v241, 0xffff0000, v184
    v_lshlrev_b32 v242, 16, v185
    v_and_b32 v243, 0xffff0000, v185
    v_lshlrev_b32 v244, 16, v186
    v_and_b32 v245, 0xffff0000, v186
    v_lshlrev_b32 v246, 16, v187
    v_and_b32 v247, 0xffff0000, v187
    v_max_f32 v16, v188, v192
    s_nop 1
    v_max_f32_dpp v16, v16, v16 row_ror:8 row_mask:0xf bank_mask:0xf
    s_nop 1
    v_max_f32_dpp v16, v16, v16 row_ror:4 row_mask:0xf bank_mask:0xf
    s_nop 1
    v_max_f32_dpp v16, v16, v16 row_ror:2 row_mask:0xf bank_mask:0xf
    s_nop 1
    v_max_f32_dpp v16, v16, v16 row_ror:1 row_mask:0xf bank_mask:0xf
    v_sub_f32 v17, v188, v16
    v_sub_f32 v18, v192, v16
    v_mul_f32 v17, s59, v17
    v_mul_f32 v18, s59, v18
    v_exp_f32 v17, v17
    v_exp_f32 v18, v18
    s_nop 0
    v_mul_f32 v16, v17, v189
    v_fmac_f32 v16, v18, v193
    v_mul_f32 v208, v224, v17
    v_mul_f32 v209, v225, v17
    v_mul_f32 v210, v226, v17
    v_mul_f32 v211, v227, v17
    v_mul_f32 v212, v228, v17
    v_mul_f32 v213, v229, v17
    v_mul_f32 v214, v230, v17
    v_mul_f32 v215, v231, v17
    v_mul_f32 v216, v232, v17
    v_mul_f32 v217, v233, v17
    v_mul_f32 v218, v234, v17
    v_mul_f32 v219, v235, v17
    v_fmac_f32 v208, v236, v18
    v_fmac_f32 v209, v237, v18
    v_fmac_f32 v210, v238, v18
    v_fmac_f32 v211, v239, v18
    v_fmac_f32 v212, v240, v18
    v_fmac_f32 v213, v241, v18
    v_fmac_f32 v214, v242, v18
    v_fmac_f32 v215, v243, v18
    v_fmac_f32 v216, v244, v18
    v_fmac_f32 v217, v245, v18
    v_fmac_f32 v218, v246, v18
    v_fmac_f32 v219, v247, v18
    v_add_f32_dpp v16, v16, v16 row_ror:8 row_mask:0xf bank_mask:0xf
    v_add_f32_dpp v208, v208, v208 row_ror:8 row_mask:0xf bank_mask:0xf
    v_add_f32_dpp v209, v209, v209 row_ror:8 row_mask:0xf bank_mask:0xf
    v_add_f32_dpp v210, v210, v210 row_ror:8 row_mask:0xf bank_mask:0xf
    v_add_f32_dpp v211, v211, v211 row_ror:8 row_mask:0xf bank_mask:0xf
    v_add_f32_dpp v212, v212, v212 row_ror:8 row_mask:0xf bank_mask:0xf
    v_add_f32_dpp v213, v213, v213 row_ror:8 row_mask:0xf bank_mask:0xf
    v_add_f32_dpp v214, v214, v214 row_ror:8 row_mask:0xf bank_mask:0xf
    v_add_f32_dpp v215, v215, v215 row_ror:8 row_mask:0xf bank_mask:0xf
    v_add_f32_dpp v216, v216, v216 row_ror:8 row_mask:0xf bank_mask:0xf
    v_add_f32_dpp v217, v217, v217 row_ror:8 row_mask:0xf bank_mask:0xf
    v_add_f32_dpp v218, v218, v218 row_ror:8 row_mask:0xf bank_mask:0xf
    v_add_f32_dpp v219, v219, v219 row_ror:8 row_mask:0xf bank_mask:0xf
    v_add_f32_dpp v16, v16, v16 row_ror:4 row_mask:0xf bank_mask:0xf
    v_add_f32_dpp v208, v208, v208 row_ror:4 row_mask:0xf bank_mask:0xf
    v_add_f32_dpp v209, v209, v209 row_ror:4 row_mask:0xf bank_mask:0xf
    v_add_f32_dpp v210, v210, v210 row_ror:4 row_mask:0xf bank_mask:0xf
    v_add_f32_dpp v211, v211, v211 row_ror:4 row_mask:0xf bank_mask:0xf
    v_add_f32_dpp v212, v212, v212 row_ror:4 row_mask:0xf bank_mask:0xf
    v_add_f32_dpp v213, v213, v213 row_ror:4 row_mask:0xf bank_mask:0xf
    v_add_f32_dpp v214, v214, v214 row_ror:4 row_mask:0xf bank_mask:0xf
    v_add_f32_dpp v215, v215, v215 row_ror:4 row_mask:0xf bank_mask:0xf
    v_add_f32_dpp v216, v216, v216 row_ror:4 row_mask:0xf bank_mask:0xf
    v_add_f32_dpp v217, v217, v217 row_ror:4 row_mask:0xf bank_mask:0xf
    v_add_f32_dpp v218, v218, v218 row_ror:4 row_mask:0xf bank_mask:0xf
    v_add_f32_dpp v219, v219, v219 row_ror:4 row_mask:0xf bank_mask:0xf
    v_add_f32_dpp v16, v16, v16 row_ror:2 row_mask:0xf bank_mask:0xf
    v_add_f32_dpp v208, v208, v208 row_ror:2 row_mask:0xf bank_mask:0xf
    v_add_f32_dpp v209, v209, v209 row_ror:2 row_mask:0xf bank_mask:0xf
    v_add_f32_dpp v210, v210, v210 row_ror:2 row_mask:0xf bank_mask:0xf
    v_add_f32_dpp v211, v211, v211 row_ror:2 row_mask:0xf bank_mask:0xf
    v_add_f32_dpp v212, v212, v212 row_ror:2 row_mask:0xf bank_mask:0xf
    v_add_f32_dpp v213, v213, v213 row_ror:2 row_mask:0xf bank_mask:0xf
    v_add_f32_dpp v214, v214, v214 row_ror:2 row_mask:0xf bank_mask:0xf
    v_add_f32_dpp v215, v215, v215 row_ror:2 row_mask:0xf bank_mask:0xf
    v_add_f32_dpp v216, v216, v216 row_ror:2 row_mask:0xf bank_mask:0xf
    v_add_f32_dpp v217, v217, v217 row_ror:2 row_mask:0xf bank_mask:0xf
    v_add_f32_dpp v218, v218, v218 row_ror:2 row_mask:0xf bank_mask:0xf
    v_add_f32_dpp v219, v219, v219 row_ror:2 row_mask:0xf bank_mask:0xf
    v_add_f32_dpp v16, v16, v16 row_ror:1 row_mask:0xf bank_mask:0xf
    v_add_f32_dpp v208, v208, v208 row_ror:1 row_mask:0xf bank_mask:0xf
    v_add_f32_dpp v209, v209, v209 row_ror:1 row_mask:0xf bank_mask:0xf
    v_add_f32_dpp v210, v210, v210 row_ror:1 row_mask:0xf bank_mask:0xf
    v_add_f32_dpp v211, v211, v211 row_ror:1 row_mask:0xf bank_mask:0xf
    v_add_f32_dpp v212, v212, v212 row_ror:1 row_mask:0xf bank_mask:0xf
    v_add_f32_dpp v213, v213, v213 row_ror:1 row_mask:0xf bank_mask:0xf
    v_add_f32_dpp v214, v214, v214 row_ror:1 row_mask:0xf bank_mask:0xf
    v_add_f32_dpp v215, v215, v215 row_ror:1 row_mask:0xf bank_mask:0xf
    v_add_f32_dpp v216, v216, v216 row_ror:1 row_mask:0xf bank_mask:0xf
    v_add_f32_dpp v217, v217, v217 row_ror:1 row_mask:0xf bank_mask:0xf
    v_add_f32_dpp v218, v218, v218 row_ror:1 row_mask:0xf bank_mask:0xf
    v_add_f32_dpp v219, v219, v219 row_ror:1 row_mask:0xf bank_mask:0xf
    v_rcp_f32 v16, v16
    s_mov_b32 exec_lo, 0xff00ff00
    s_mov_b32 exec_hi, 0xff00ff00
    v_mul_f32 v208, v208, v16
    v_mul_f32 v209, v209, v16
    v_mul_f32 v210, v210, v16
    v_mul_f32 v211, v211, v16
    v_mul_f32 v212, v212, v16
    v_mul_f32 v213, v213, v16
    v_mul_f32 v214, v214, v16
    v_mul_f32 v215, v215, v16
    v_mul_f32 v216, v216, v16
    v_mul_f32 v217, v217, v16
    v_mul_f32 v218, v218, v16
    v_mul_f32 v219, v219, v16
    v_cvt_pk_bf16_f32 v32, v208, v208
    v_cvt_pk_bf16_f32 v33, v209, v209
    v_cvt_pk_bf16_f32 v34, v210, v210
    v_cvt_pk_bf16_f32 v35, v211, v211
    v_cvt_pk_bf16_f32 v36, v212, v212
    v_cvt_pk_bf16_f32 v37, v213, v213
    v_cvt_pk_bf16_f32 v38, v214, v214
    v_cvt_pk_bf16_f32 v39, v215, v215
    v_cvt_pk_bf16_f32 v40, v216, v216
    v_cvt_pk_bf16_f32 v41, v217, v217
    v_cvt_pk_bf16_f32 v42, v218, v218
    v_cvt_pk_bf16_f32 v43, v219, v219
    s_mov_b64 exec, -1
L_nog1:
    v_and_b32 v52, v32, v4
    v_and_b32 v53, v32, v5
    v_and_b32 v54, v32, v6
    v_and_b32 v55, v32, v7
    v_and_b32 v56, v33, v4
    v_and_b32 v57, v33, v5
    v_and_b32 v58, v33, v6
    v_and_b32 v59, v33, v7
    v_mfma_f32_16x16x32_bf16 v[48:51], v[64:67], v[52:55], 0
    v_and_b32 v52, v34, v4
    v_and_b32 v53, v34, v5
    v_and_b32 v54, v34, v6
    v_and_b32 v55, v34, v7
    v_mfma_f32_16x16x32_bf16 v[48:51], v[68:71], v[56:59], v[48:51]
    v_and_b32 v56, v35, v4
    v_and_b32 v57, v35, v5
    v_and_b32 v58, v35, v6
    v_and_b32 v59, v35, v7
    v_mfma_f32_16x16x32_bf16 v[48:51], v[72:75], v[52:55], v[48:51]
    v_and_b32 v52, v36, v4
    v_and_b32 v53, v36, v5
    v_and_b32 v54, v36, v6
    v_and_b32 v55, v36, v7
    v_mfma_f32_16x16x32_bf16 v[48:51], v[76:79], v[56:59], v[48:51]
    v_and_b32 v56, v37, v4
    v_and_b32 v57, v37, v5
    v_and_b32 v58, v37, v6
    v_and_b32 v59, v37, v7
    v_mfma_f32_16x16x32_bf16 v[48:51], v[80:83], v[52:55], v[48:51]
    v_and_b32 v52, v38, v4
    v_and_b32 v53, v38, v5
    v_and_b32 v54, v38, v6
    v_and_b32 v55, v38, v7
    v_mfma_f32_16x16x32_bf16 v[48:51], v[84:87], v[56:59], v[48:51]
    v_and_b32 v56, v39, v4
    v_and_b32 v57, v39, v5
    v_and_b32 v58, v39, v6
    v_and_b32 v59, v39, v7
    v_mfma_f32_16x16x32_bf16 v[48:51], v[88:91], v[52:55], v[48:51]
    v_and_b32 v52, v40, v4
    v_and_b32 v53, v40, v5
    v_and_b32 v54, v40, v6
    v_and_b32 v55, v40, v7
    v_mfma_f32_16x16x32_bf16 v[48:51], v[92:95], v[56:59], v[48:51]
    v_and_b32 v56, v41, v4
    v_and_b32 v57, v41, v5
    v_and_b32 v58, v41, v6
    v_and_b32 v59, v41, v7
    v_mfma_f32_16x16x32_bf16 v[48:51], v[96:99], v[52:55], v[48:51]
    v_and_b32 v52, v42, v4
    v_and_b32 v53, v42, v5
    v_and_b32 v54, v42, v6
    v_and_b32 v55, v42, v7
    v_mfma_f32_16x16x32_bf16 v[48:51], v[100:103], v[56:59], v[48:51]
    v_and_b32 v56, v43, v4
    v_and_b32 v57, v43, v5
    v_and_b32 v58, v43, v6
    v_and_b32 v59, v43, v7
    v_mfma_f32_16x16x32_bf16 v[48:51], v[104:107], v[52:55], v[48:51]
    s_nop 1
    v_mfma_f32_16x16x32_bf16 v[48:51], v[108:111], v[56:59], v[48:51]
    s_nop 7
    ds_write_b128 v13, v[48:51] offset:13568
    s_waitcnt lgkmcnt(0)
    s_cmp_eq_u32 s98, 0
    s_cbranch_scc1 L_nb19
    s_barrier
L_nb19:
    ds_read_b32 v32, v11 offset:13568
    ds_read_b32 v33, v11 offset:14592
    ds_read_b32 v34, v11 offset:15616
    ds_read_b32 v35, v11 offset:16640
    s_waitcnt lgkmcnt(0)
    v_add_f32 v32, v32, v33
    v_add_f32 v34, v34, v35
    v_add_f32 v32, v32, v34
    v_min_u32 v32, -2, v32
    buffer_store_dword v32, v12, s[68:71], s12 offen sc1
    s_branch L_texit
L_ffn1:
    v_mul_u32_u24 v8, 40, v1
    v_and_b32 v9, 1, v1
    v_mul_u32_u24 v9, 1280, v9
    v_lshl_add_u32 v9, v3, 4, v9
    s_mul_i32 s8, s7, 320
    v_add_u32 v9, s8, v9
    v_lshlrev_b32 v10, 3, v1
    s_lshl_b32 s8, s7, 9
    v_add_u32 v10, s8, v10
    v_and_b32 v11, 1, v1
    v_lshlrev_b32 v11, 7, v11
    v_bfe_u32 v12, v1, 1, 4
    v_lshl_add_u32 v11, v12, 3, v11
    v_lshrrev_b32 v12, 5, v1
    v_lshl_add_u32 v11, v12, 2, v11
    v_mul_u32_u24 v12, 3072, v12
    v_and_b32 v13, 30, v1
    v_lshl_add_u32 v12, v13, 1, v12
    v_and_b32 v13, 1, v1
    v_mul_u32_u24 v13, 6144, v13
    v_add_u32 v12, v12, v13
    v_cmp_eq_u32 s[50:51], 0, v13
    s_lshl_b32 s9, s85, 6
    s_add_u32 s9, s9, 827392
    s_add_u32 s10, s9, 12288
    s_add_u32 s52, s9, 24576
    s_add_u32 s53, s9, 36864
    s_and_b32 s8, s85, 7
    s_mul_i32 s8, s8, 2560
    s_add_u32 s8, s8, 786432
    s_and_b32 s11, s85, 7
    s_mul_i32 s11, s11, 35840
    s_lshl_b32 s12, s85, 6
    s_add_u32 s11, s11, s12
    s_add_u32 s11, s11, 4006912
    s_cmp_lg_u32 s7, 0
    s_cbranch_scc1 L_f1_wait
    s_mov_b32 s14, 262144
    s_mov_b32 exec_lo, 0x00000001
    s_mov_b32 exec_hi, 0x00000000
L_pp20:
    buffer_load_dword v32, v8, s[68:71], s11 offen sc1
    s_waitcnt vmcnt(0)
    v_cmp_eq_u32 vcc, -1, v32
    s_bcnt1_i32_b64 s99, vcc
    s_cmp_le_u32 s99, 0
    s_cbranch_scc1 L_pp20_done
    s_sleep 4
    s_sub_u32 s14, s14, 1
    s_cbranch_scc0 L_pp20
L_pp20_done:
    s_mov_b64 exec, -1
    s_mov_b32 s14, 262144
L_poll21:
    buffer_load_dwordx4 v[32:35], v8, s[68:71], s8 offen sc1
    buffer_load_dwordx4 v[36:39], v8, s[68:71], s8 offen offset:16 sc1
    buffer_load_dwordx2 v[40:41], v8, s[68:71], s8 offen offset:32 sc1
L_poll21_chk:
    s_waitcnt vmcnt(0)
    v_max_u32 v14, v32, v33
    v_max3_u32 v14, v14, v34, v35
    v_max3_u32 v14, v14, v36, v37
    v_max3_u32 v14, v14, v38, v39
    v_max3_u32 v14, v14, v40, v41
    v_cmp_eq_u32 vcc, -1, v14
    s_cbranch_vccz L_poll21_done
    s_mov_b64 exec, vcc
    s_sleep 3
    s_sub_u32 s14, s14, 1
    s_cbranch_scc0 L_poll21
L_poll21_done:
    s_mov_b64 exec, -1
    v_lshlrev_b32 v176, 16, v32
    v_and_b32 v177, 0xffff0000, v32
    v_lshlrev_b32 v178, 16, v33
    v_and_b32 v179, 0xffff0000, v33
    v_lshlrev_b32 v180, 16, v34
    v_and_b32 v181, 0xffff0000, v34
    v_lshlrev_b32 v182, 16, v35
    v_and_b32 v183, 0xffff0000, v35
    v_lshlrev_b32 v184, 16, v36
    v_and_b32 v185, 0xffff0000, v36
    v_lshlrev_b32 v186, 16, v37
    v_and_b32 v187, 0xffff0000, v37
    v_lshlrev_b32 v188, 16, v38
    v_and_b32 v189, 0xffff0000, v38
    v_lshlrev_b32 v190, 16, v39
    v_and_b32 v191, 0xffff0000, v39
    v_lshlrev_b32 v192, 16, v40
    v_and_b32 v193, 0xffff0000, v40
    v_lshlrev_b32 v194, 16, v41
    v_and_b32 v195, 0xffff0000, v41
    v_pk_add_f32 v[44:45], v[176:177], v[178:179]
    v_pk_add_f32 v[46:47], v[180:181], v[182:183]
    v_pk_add_f32 v[44:45], v[44:45], v[184:185]
    v_pk_add_f32 v[46:47], v[46:47], v[186:187]
    v_pk_add_f32 v[44:45], v[44:45], v[188:189]
    v_pk_add_f32 v[46:47], v[46:47], v[190:191]
    v_pk_add_f32 v[44:45], v[44:45], v[192:193]
    v_pk_add_f32 v[46:47], v[46:47], v[194:195]
    v_pk_add_f32 v[44:45], v[44:45], v[46:47]
    v_add_f32 v44, v44, v45
    s_nop 1
    v_add_f32_dpp v44, v44, v44 row_ror:8 row_mask:0xf bank_mask:0xf
    s_nop 1
    v_add_f32_dpp v44, v44, v44 row_ror:4 row_mask:0xf bank_mask:0xf
    s_nop 1
    v_add_f32_dpp v44, v44, v44 row_ror:2 row_mask:0xf bank_mask:0xf
    s_nop 1
    v_add_f32_dpp v44, v44, v44 row_ror:1 row_mask:0xf bank_mask:0xf
    v_mov_b32 v46, v44
    s_nop 1
    v_permlane16_swap_b32 v44, v46
    s_nop 1
    v_add_f32 v44, v44, v46
    v_mul_f32 v48, 0xbacccccd, v44
    v_mul_f32 v49, 0xbacccccd, v44
    v_pk_add_f32 v[46:47], v[176:177], v[48:49]
    v_pk_mul_f32 v[44:45], v[46:47], v[46:47]
    v_pk_add_f32 v[50:51], v[178:179], v[48:49]
    v_pk_fma_f32 v[44:45], v[50:51], v[50:51], v[44:45]
    v_pk_add_f32 v[46:47], v[180:181], v[48:49]
    v_pk_fma_f32 v[44:45], v[46:47], v[46:47], v[44:45]
    v_pk_add_f32 v[50:51], v[182:183], v[48:49]
    v_pk_fma_f32 v[44:45], v[50:51], v[50:51], v[44:45]
    v_pk_add_f32 v[46:47], v[184:185], v[48:49]
    v_pk_fma_f32 v[44:45], v[46:47], v[46:47], v[44:45]
    v_pk_add_f32 v[50:51], v[186:187], v[48:49]
    v_pk_fma_f32 v[44:45], v[50:51], v[50:51], v[44:45]
    v_pk_add_f32 v[46:47], v[188:189], v[48:49]
    v_pk_fma_f32 v[44:45], v[46:47], v[46:47], v[44:45]
    v_pk_add_f32 v[50:51], v[190:191], v[48:49]
    v_pk_fma_f32 v[44:45], v[50:51], v[50:51], v[44:45]
    v_pk_add_f32 v[46:47], v[192:193], v[48:49]
    v_pk_fma_f32 v[44:45], v[46:47], v[46:47], v[44:45]
    v_pk_add_f32 v[50:51], v[194:195], v[48:49]
    v_pk_fma_f32 v[44:45], v[50:51], v[50:51], v[44:45]
    v_add_f32 v44, v44, v45
    v_cvt_pk_bf16_f32 v48, v48, v48
    v_lshlrev_b32 v48, 16, v48
    v_add_f32_dpp v44, v44, v44 row_ror:8 row_mask:0xf bank_mask:0xf
    v_mov_b32 v49, v48
    v_pk_add_f32 v[176:177], v[176:177], v[48:49]
    v_add_f32_dpp v44, v44, v44 row_ror:4 row_mask:0xf bank_mask:0xf
    v_pk_add_f32 v[178:179], v[178:179], v[48:49]
    v_pk_add_f32 v[180:181], v[180:181], v[48:49]
    v_add_f32_dpp v44, v44, v44 row_ror:2 row_mask:0xf bank_mask:0xf
    v_pk_add_f32 v[182:183], v[182:183], v[48:49]
    v_pk_add_f32 v[184:185], v[184:185], v[48:49]
    v_add_f32_dpp v44, v44, v44 row_ror:1 row_mask:0xf bank_mask:0xf
    v_pk_add_f32 v[186:187], v[186:187], v[48:49]
    v_pk_add_f32 v[188:189], v[188:189], v[48:49]
    v_mov_b32 v46, v44
    v_pk_add_f32 v[190:191], v[190:191], v[48:49]
    v_pk_add_f32 v[192:193], v[192:193], v[48:49]
    v_permlane16_swap_b32 v44, v46
    v_pk_add_f32 v[194:195], v[194:195], v[48:49]
    v_cvt_pk_bf16_f32 v176, v176, v177
    v_add_f32 v44, v44, v46
    v_mul_f32 v50, 0x3acccccd, v44
    v_cvt_pk_bf16_f32 v50, v50, v50
    v_lshlrev_b32 v50, 16, v50
    v_add_f32 v50, 0x3727c5ac, v50
    v_cvt_pk_bf16_f32 v50, v50, v50
    v_lshlrev_b32 v50, 16, v50
    v_sqrt_f32 v50, v50
    v_cvt_pk_bf16_f32 v178, v178, v179
    v_cvt_pk_bf16_f32 v50, v50, v50
    v_lshlrev_b32 v50, 16, v50
    v_rcp_f32 v50, v50
    v_cvt_pk_bf16_f32 v180, v180, v181
    v_mov_b32 v51, v50
    v_cvt_pk_bf16_f32 v182, v182, v183
    v_cvt_pk_bf16_f32 v184, v184, v185
    v_cvt_pk_bf16_f32 v186, v186, v187
    v_cvt_pk_bf16_f32 v188, v188, v189
    v_cvt_pk_bf16_f32 v190, v190, v191
    v_cvt_pk_bf16_f32 v192, v192, v193
    v_cvt_pk_bf16_f32 v194, v194, v195
    v_and_b32 v177, 0xffff0000, v176
    v_lshlrev_b32 v176, 16, v176
    v_and_b32 v179, 0xffff0000, v178
    v_lshlrev_b32 v178, 16, v178
    v_and_b32 v181, 0xffff0000, v180
    v_lshlrev_b32 v180, 16, v180
    v_and_b32 v183, 0xffff0000, v182
    v_lshlrev_b32 v182, 16, v182
    v_and_b32 v185, 0xffff0000, v184
    v_lshlrev_b32 v184, 16, v184
    v_and_b32 v187, 0xffff0000, v186
    v_lshlrev_b32 v186, 16, v186
    v_and_b32 v189, 0xffff0000, v188
    v_lshlrev_b32 v188, 16, v188
    v_and_b32 v191, 0xffff0000, v190
    v_lshlrev_b32 v190, 16, v190
    v_and_b32 v193, 0xffff0000, v192
    v_lshlrev_b32 v192, 16, v192
    v_and_b32 v195, 0xffff0000, v194
    v_lshlrev_b32 v194, 16, v194
    v_pk_mul_f32 v[176:177], v[176:177], v[50:51]
    v_pk_mul_f32 v[178:179], v[178:179], v[50:51]
    v_pk_mul_f32 v[180:181], v[180:181], v[50:51]
    v_pk_mul_f32 v[182:183], v[182:183], v[50:51]
    v_pk_mul_f32 v[184:185], v[184:185], v[50:51]
    v_pk_mul_f32 v[186:187], v[186:187], v[50:51]
    v_pk_mul_f32 v[188:189], v[188:189], v[50:51]
    v_pk_mul_f32 v[190:191], v[190:191], v[50:51]
    v_pk_mul_f32 v[192:193], v[192:193], v[50:51]
    v_pk_mul_f32 v[194:195], v[194:195], v[50:51]
    v_cvt_pk_bf16_f32 v52, v176, v177
    v_cvt_pk_bf16_f32 v53, v178, v179
    v_cvt_pk_bf16_f32 v54, v180, v181
    v_cvt_pk_bf16_f32 v55, v182, v183
    v_cvt_pk_bf16_f32 v56, v184, v185
    v_cvt_pk_bf16_f32 v57, v186, v187
    v_cvt_pk_bf16_f32 v58, v188, v189
    v_cvt_pk_bf16_f32 v59, v190, v191
    v_cvt_pk_bf16_f32 v60, v192, v193
    v_cvt_pk_bf16_f32 v61, v194, v195
    ds_write_b64 v8, v[52:53] offset:17664
    ds_write_b64 v8, v[54:55] offset:17672
    ds_write_b64 v8, v[56:57] offset:17680
    ds_write_b64 v8, v[58:59] offset:17688
    ds_write_b64 v8, v[60:61] offset:17696
    s_waitcnt lgkmcnt(0)
L_f1_wait:
    s_cmp_eq_u32 s98, 0
    s_cbranch_scc1 L_nb22
    s_barrier
L_nb22:
    ds_read_b128 v[196:199], v9 offset:17664
    ds_read_b128 v[200:203], v9 offset:17728
    ds_read_b128 v[204:207], v9 offset:17792
    ds_read_b128 v[208:211], v9 offset:17856
    ds_read_b128 v[212:215], v9 offset:17920
    s_waitcnt lgkmcnt(4)
    v_mfma_f32_16x16x32_bf16 v[216:219], v[196:199], v[64:67], 0
    v_mfma_f32_16x16x32_bf16 v[220:223], v[196:199], v[68:71], 0
    v_mfma_f32_16x16x32_bf16 v[224:227], v[196:199], v[104:107], 0
    v_mfma_f32_16x16x32_bf16 v[228:231], v[196:199], v[108:111], 0
    s_waitcnt lgkmcnt(3)
    v_mfma_f32_16x16x32_bf16 v[216:219], v[200:203], v[72:75], v[216:219]
    v_mfma_f32_16x16x32_bf16 v[220:223], v[200:203], v[76:79], v[220:223]
    v_mfma_f32_16x16x32_bf16 v[224:227], v[200:203], v[112:115], v[224:227]
    v_mfma_f32_16x16x32_bf16 v[228:231], v[200:203], v[116:119], v[228:231]
    s_waitcnt lgkmcnt(2)
    v_mfma_f32_16x16x32_bf16 v[216:219], v[204:207], v[80:83], v[216:219]
    v_mfma_f32_16x16x32_bf16 v[220:223], v[204:207], v[84:87], v[220:223]
    v_mfma_f32_16x16x32_bf16 v[224:227], v[204:207], v[120:123], v[224:227]
    v_mfma_f32_16x16x32_bf16 v[228:231], v[204:207], v[124:127], v[228:231]
    s_waitcnt lgkmcnt(1)
    v_mfma_f32_16x16x32_bf16 v[216:219], v[208:211], v[88:91], v[216:219]
    v_mfma_f32_16x16x32_bf16 v[220:223], v[208:211], v[92:95], v[220:223]
    v_mfma_f32_16x16x32_bf16 v[224:227], v[208:211], v[128:131], v[224:227]
    v_mfma_f32_16x16x32_bf16 v[228:231], v[208:211], v[132:135], v[228:231]
    s_waitcnt lgkmcnt(0)
    v_mfma_f32_16x16x32_bf16 v[216:219], v[212:215], v[96:99], v[216:219]
    v_mfma_f32_16x16x32_bf16 v[220:223], v[212:215], v[100:103], v[220:223]
    v_mfma_f32_16x16x32_bf16 v[224:227], v[212:215], v[136:139], v[224:227]
    v_mfma_f32_16x16x32_bf16 v[228:231], v[212:215], v[140:143], v[228:231]
    s_nop 7
    s_mov_b64 exec, 0xffff
    ds_write_b64 v10, v[216:217] offset:13568
    ds_write_b64 v10, v[220:221] offset:13696
    ds_write_b64 v10, v[224:225] offset:13824
    ds_write_b64 v10, v[228:229] offset:13952
    s_mov_b64 exec, -1
    s_waitcnt lgkmcnt(0)
    s_cmp_eq_u32 s98, 0
    s_cbranch_scc1 L_nb23
    s_barrier
L_nb23:
    s_cmp_lg_u32 s7, 0
    s_cbranch_scc1 L_texit
    ds_read_b32 v232, v11 offset:13568
    ds_read_b32 v236, v11 offset:13824
    ds_read_b32 v233, v11 offset:14080
    ds_read_b32 v237, v11 offset:14336
    ds_read_b32 v234, v11 offset:14592
    ds_read_b32 v238, v11 offset:14848
    ds_read_b32 v235, v11 offset:15104
    ds_read_b32 v239, v11 offset:15360
    s_waitcnt lgkmcnt(0)
    v_add_f32 v232, v232, v233
    v_add_f32 v234, v234, v235
    v_add_f32 v232, v232, v234
    v_cvt_pk_bf16_f32 v232, v232, v232
    v_lshlrev_b32 v232, 16, v232
    v_add_f32 v236, v236, v237
    v_add_f32 v238, v238, v239
    v_add_f32 v236, v236, v238
    v_cvt_pk_bf16_f32 v236, v236, v236
    v_lshlrev_b32 v236, 16, v236
    v_mul_f32 v233, v232, v232
    v_mov_b32 v234, 0xc0135761
    v_fmac_f32 v234, 0xbdd2d3e8, v233
    v_mul_f32 v234, v234, v232
    v_exp_f32 v234, v234
    s_nop 0
    v_add_f32 v234, 1.0, v234
    v_rcp_f32 v234, v234
    s_nop 0
    v_mul_f32 v232, v232, v234
    v_cvt_pk_bf16_f32 v232, v232, v232
    v_lshlrev_b32 v232, 16, v232
    v_mul_f32 v232, v232, v236
    s_nop 1
    v_mov_b32_dpp v233, v232 quad_perm:[1,0,3,2] row_mask:0xf bank_mask:0xf
    v_cvt_pk_bf16_f32 v234, v232, v233
    v_cvt_pk_bf16_f32 v235, v233, v232
    v_cndmask_b32 v232, v235, v234, s[50:51]
    v_min_u32 v232, -2, v232
    buffer_store_dword v232, v12, s[68:71], s9 offen sc1
    buffer_store_dword v232, v12, s[68:71], s10 offen sc1
    buffer_store_dword v232, v12, s[68:71], s52 offen sc1
    buffer_store_dword v232, v12, s[68:71], s53 offen sc1
    s_branch L_texit
L_red:
    s_cmp_ge_u32 s7, 2
    s_cbranch_scc1 L_texit
    v_lshrrev_b32 v8, 3, v1
    v_mul_u32_u24 v8, 35840, v8
    v_and_b32 v9, 7, v1
    v_lshl_add_u32 v8, v9, 4, v8
    s_lshl_b32 s8, s85, 7
    s_mul_i32 s9, s7, 2560
    s_add_u32 s8, s8, s9
    s_add_u32 s8, s8, 3146752
    s_add_u32 s9, s8, 286720
    s_add_u32 s10, s8, 573440
    s_add_u32 s11, s8, 860160
    v_lshlrev_b32 v9, 3, v9
    v_lshrrev_b32 v10, 5, v1
    v_lshl_add_u32 v9, v10, 2, v9
    s_lshl_b32 s12, s85, 6
    s_mul_i32 s13, s7, 1280
    s_add_u32 s12, s12, s13
    buffer_load_dword v52, v9, s[72:75], s12 offen
    s_add_u32 s12, s12, 786432
    s_add_u32 s13, s12, 10240
    s_add_u32 s52, s12, 20480
    s_add_u32 s53, s12, 30720
    v_bfe_u32 v10, v1, 3, 2
    v_mul_u32_u24 v10, 2560, v10
    v_add_u32 v10, v9, v10
    s_waitcnt vmcnt(0)
    v_lshlrev_b32 v53, 16, v52
    v_and_b32 v54, 0xffff0000, v52
    s_mov_b32 s14, 262144
    s_mov_b32 exec_lo, 0x00000001
    s_mov_b32 exec_hi, 0x00000001
L_pp24:
    buffer_load_dword v32, v8, s[68:71], s11 offen sc1
    s_waitcnt vmcnt(0)
    v_cmp_eq_u32 vcc, -1, v32
    s_bcnt1_i32_b64 s99, vcc
    s_cmp_le_u32 s99, 1
    s_cbranch_scc1 L_pp24_done
    s_sleep 4
    s_sub_u32 s14, s14, 1
    s_cbranch_scc0 L_pp24
L_pp24_done:
    s_mov_b64 exec, -1
    s_mov_b32 s14, 262144
L_poll25:
    buffer_load_dwordx4 v[32:35], v8, s[68:71], s8 offen sc1
    buffer_load_dwordx4 v[36:39], v8, s[68:71], s9 offen sc1
    buffer_load_dwordx4 v[40:43], v8, s[68:71], s10 offen sc1
    buffer_load_dwordx4 v[44:47], v8, s[68:71], s11 offen sc1
L_poll25_chk:
    s_waitcnt vmcnt(0)
    v_max_u32 v14, v32, v33
    v_max3_u32 v14, v14, v34, v35
    v_max3_u32 v14, v14, v36, v37
    v_max3_u32 v14, v14, v38, v39
    v_max3_u32 v14, v14, v40, v41
    v_max3_u32 v14, v14, v42, v43
    v_max3_u32 v14, v14, v44, v45
    v_max3_u32 v14, v14, v46, v47
    v_cmp_eq_u32 vcc, -1, v14
    s_cbranch_vccz L_poll25_done
    s_mov_b64 exec, vcc
    s_sleep 1
    s_sub_u32 s14, s14, 1
    s_cbranch_scc0 L_poll25
L_poll25_done:
    s_mov_b64 exec, -1
    v_pk_add_f32 v[32:33], v[32:33], v[36:37]
    v_pk_add_f32 v[34:35], v[34:35], v[38:39]
    v_pk_add_f32 v[40:41], v[40:41], v[44:45]
    v_pk_add_f32 v[42:43], v[42:43], v[46:47]
    v_pk_add_f32 v[32:33], v[32:33], v[40:41]
    v_pk_add_f32 v[34:35], v[34:35], v[42:43]
    s_nop 1
    v_permlane32_swap_b32 v32, v34
    v_permlane32_swap_b32 v33, v35
    s_nop 1
    v_add_f32 v32, v32, v34
    v_add_f32 v33, v33, v35
    v_mov_b32 v34, v32
    v_mov_b32 v35, v33
    s_nop 1
    v_permlane16_swap_b32 v32, v34
    v_permlane16_swap_b32 v33, v35
    s_nop 1
    v_add_f32 v32, v32, v34
    v_add_f32 v33, v33, v35
    s_nop 0
    v_add_f32_dpp v32, v32, v32 row_ror:8 row_mask:0xf bank_mask:0xf
    s_nop 0
    v_add_f32_dpp v33, v33, v33 row_ror:8 row_mask:0xf bank_mask:0xf
    v_cvt_pk_bf16_f32 v32, v32, v33
    v_and_b32 v33, 0xffff0000, v32
    v_lshlrev_b32 v32, 16, v32
    v_add_f32 v32, v32, v53
    v_add_f32 v33, v33, v54
    v_cvt_pk_bf16_f32 v32, v32, v33
    v_min_u32 v32, -2, v32
    buffer_store_dword v32, v10, s[68:71], s12 offen sc1
    buffer_store_dword v32, v10, s[68:71], s13 offen sc1
    buffer_store_dword v32, v10, s[68:71], s52 offen sc1
    s_branch L_texit
L_ffn2:
    v_lshrrev_b32 v12, 5, v1
    v_and_b32 v13, 31, v1
    v_mul_u32_u24 v13, 24, v13
    v_mul_u32_u24 v12, 3072, v12
    v_add_u32 v12, v12, v13
    s_mul_i32 s12, s7, 768
    v_add_u32 v12, s12, v12
    v_and_b32 v13, 1, v1
    v_mul_u32_u24 v13, 3072, v13
    v_lshl_add_u32 v13, v3, 4, v13
    v_add_u32 v13, s12, v13
    v_lshlrev_b32 v15, 3, v1
    s_lshl_b32 s12, s7, 8
    v_add_u32 v15, s12, v15
    v_and_b32 v16, 1, v1
    v_lshlrev_b32 v16, 7, v16
    v_bfe_u32 v17, v1, 1, 4
    v_lshl_add_u32 v16, v17, 3, v16
    v_lshrrev_b32 v17, 5, v1
    v_lshl_add_u32 v16, v17, 2, v16
    v_mul_u32_u24 v17, 1280, v17
    v_and_b32 v18, 30, v1
    v_lshl_add_u32 v17, v18, 1, v17
    s_and_b32 s12, s85, 7
    s_mul_i32 s12, s12, 6144
    s_add_u32 s12, s12, 827392
    s_lshl_b32 s10, s85, 6
    s_add_u32 s11, s7, 8
    s_mul_i32 s11, s11, 2560
    s_add_u32 s11, s11, s10
    s_add_u32 s11, s11, 786432
    s_mov_b32 s76, s34
    s_mov_b32 s77, s35
    s_and_b32 s78, s98, 2560
    s_mov_b32 s79, 0x00020000
    s_mov_b32 s14, 262144
L_poll26:
    buffer_load_dword v40, v17, s[68:71], s11 offen sc1
L_poll26_chk:
    s_waitcnt vmcnt(0)
    v_cmp_eq_u32 vcc, -1, v40
    s_cbranch_vccz L_poll26_done
    s_mov_b64 exec, vcc
    s_sleep 4
    s_sub_u32 s14, s14, 1
    s_cbranch_scc0 L_poll26
L_poll26_done:
    s_mov_b64 exec, -1
    v_lshlrev_b32 v41, 16, v40
    v_and_b32 v42, 0xffff0000, v40
    s_mov_b32 s14, 262144
L_poll27:
    buffer_load_dwordx2 v[44:45], v12, s[68:71], s12 offen offset:0 sc1
    buffer_load_dwordx2 v[46:47], v12, s[68:71], s12 offen offset:8 sc1
    buffer_load_dwordx2 v[48:49], v12, s[68:71], s12 offen offset:16 sc1
L_poll27_chk:
    s_waitcnt vmcnt(0)
    v_max_u32 v14, v44, v45
    v_max3_u32 v14, v14, v46, v47
    v_max3_u32 v14, v14, v48, v49
    v_cmp_eq_u32 vcc, -1, v14
    s_cbranch_vccz L_poll27_done
    s_mov_b64 exec, vcc
    s_sleep 1
    s_sub_u32 s14, s14, 1
    s_cbranch_scc0 L_poll27
L_poll27_done:
    s_mov_b64 exec, -1
    ds_write_b64 v12, v[44:45] offset:20224
    ds_write_b64 v12, v[46:47] offset:20232
    ds_write_b64 v12, v[48:49] offset:20240
    s_waitcnt lgkmcnt(0)
    ds_read_b128 v[176:179], v13 offset:20224
    ds_read_b128 v[180:183], v13 offset:20288
    ds_read_b128 v[184:187], v13 offset:20352
    ds_read_b128 v[188:191], v13 offset:20416
    ds_read_b128 v[192:195], v13 offset:20480
    ds_read_b128 v[196:199], v13 offset:20544
    ds_read_b128 v[200:203], v13 offset:20608
    ds_read_b128 v[204:207], v13 offset:20672
    ds_read_b128 v[208:211], v13 offset:20736
    ds_read_b128 v[212:215], v13 offset:20800
    ds_read_b128 v[216:219], v13 offset:20864
    ds_read_b128 v[220:223], v13 offset:20928
    s_waitcnt lgkmcnt(11)
    v_mfma_f32_16x16x32_bf16 v[224:227], v[176:179], v[64:67], 0
    v_mfma_f32_16x16x32_bf16 v[228:231], v[176:179], v[68:71], 0
    s_waitcnt lgkmcnt(10)
    v_mfma_f32_16x16x32_bf16 v[224:227], v[180:183], v[72:75], v[224:227]
    v_mfma_f32_16x16x32_bf16 v[228:231], v[180:183], v[76:79], v[228:231]
    s_waitcnt lgkmcnt(9)
    v_mfma_f32_16x16x32_bf16 v[224:227], v[184:187], v[80:83], v[224:227]
    v_mfma_f32_16x16x32_bf16 v[228:231], v[184:187], v[84:87], v[228:231]
    s_waitcnt lgkmcnt(8)
    v_mfma_f32_16x16x32_bf16 v[224:227], v[188:191], v[88:91], v[224:227]
    v_mfma_f32_16x16x32_bf16 v[228:231], v[188:191], v[92:95], v[228:231]
    s_waitcnt lgkmcnt(7)
    v_mfma_f32_16x16x32_bf16 v[224:227], v[192:195], v[96:99], v[224:227]
    v_mfma_f32_16x16x32_bf16 v[228:231], v[192:195], v[100:103], v[228:231]
    s_waitcnt lgkmcnt(6)
    v_mfma_f32_16x16x32_bf16 v[224:227], v[196:199], v[104:107], v[224:227]
    v_mfma_f32_16x16x32_bf16 v[228:231], v[196:199], v[108:111], v[228:231]
    s_waitcnt lgkmcnt(5)
    v_mfma_f32_16x16x32_bf16 v[224:227], v[200:203], v[112:115], v[224:227]
    v_mfma_f32_16x16x32_bf16 v[228:231], v[200:203], v[116:119], v[228:231]
    s_waitcnt lgkmcnt(4)
    v_mfma_f32_16x16x32_bf16 v[224:227], v[204:207], v[120:123], v[224:227]
    v_mfma_f32_16x16x32_bf16 v[228:231], v[204:207], v[124:127], v[228:231]
    s_waitcnt lgkmcnt(3)
    v_mfma_f32_16x16x32_bf16 v[224:227], v[208:211], v[128:131], v[224:227]
    v_mfma_f32_16x16x32_bf16 v[228:231], v[208:211], v[132:135], v[228:231]
    s_waitcnt lgkmcnt(2)
    v_mfma_f32_16x16x32_bf16 v[224:227], v[212:215], v[136:139], v[224:227]
    v_mfma_f32_16x16x32_bf16 v[228:231], v[212:215], v[140:143], v[228:231]
    s_waitcnt lgkmcnt(1)
    v_mfma_f32_16x16x32_bf16 v[224:227], v[216:219], v[144:147], v[224:227]
    v_mfma_f32_16x16x32_bf16 v[228:231], v[216:219], v[148:151], v[228:231]
    s_waitcnt lgkmcnt(0)
    v_mfma_f32_16x16x32_bf16 v[224:227], v[220:223], v[152:155], v[224:227]
    v_mfma_f32_16x16x32_bf16 v[228:231], v[220:223], v[156:159], v[228:231]
    s_nop 7
    s_mov_b64 exec, 0xffff
    ds_write_b64 v15, v[224:225] offset:13568
    ds_write_b64 v15, v[228:229] offset:13696
    s_mov_b64 exec, -1
    s_waitcnt lgkmcnt(0)
    s_cmp_eq_u32 s98, 0
    s_cbranch_scc1 L_nb28
    s_barrier
L_nb28:
    s_cmp_lg_u32 s7, 0
    s_cbranch_scc1 L_f2x
    ds_read_b32 v32, v16 offset:13568
    ds_read_b32 v33, v16 offset:13824
    ds_read_b32 v34, v16 offset:14080
    ds_read_b32 v35, v16 offset:14336
    s_waitcnt lgkmcnt(0)
    v_add_f32 v32, v32, v33
    v_add_f32 v34, v34, v35
    v_add_f32 v32, v32, v34
    v_cvt_pk_bf16_f32 v32, v32, v32
    v_lshlrev_b32 v32, 16, v32
    s_nop 1
    v_mov_b32_dpp v33, v32 quad_perm:[1,0,3,2] row_mask:0xf bank_mask:0xf
    v_add_f32 v32, v32, v41
    v_add_f32 v33, v33, v42
    v_cvt_pk_bf16_f32 v32, v32, v33
    s_mov_b32 exec_lo, 0x55555555
    s_mov_b32 exec_hi, 0x55555555
    buffer_store_dword v32, v17, s[76:79], s10 offen
    s_cmp_lg_u32 s85, 0
    s_cbranch_scc1 L_noep
    v_mov_b32 v33, s15
    v_mov_b32 v34, 8192
    s_mov_b64 exec, 1
    buffer_store_dword v33, v34, s[68:71], 0 offen sc1
L_noep:
    s_mov_b64 exec, -1
L_f2x:
L_texit:
    s_cmp_lg_u32 s98, 0
    s_cbranch_scc1 L_end
    s_waitcnt vmcnt(0) lgkmcnt(0)
    s_mov_b32 s98, -1
    s_branch L_tail
L_end:
    s_endpgm
.section .rodata,"a"
.p2align 6
.amdhsa_kernel sequential_preLN__mha_block_cached__geglu_ffn__decode_kernel
  .amdhsa_next_free_vgpr 256
  .amdhsa_next_free_sgpr 102
  .amdhsa_accum_offset 256
  .amdhsa_group_segment_fixed_size 0
  .amdhsa_kernarg_size 96
  .amdhsa_user_sgpr_count 2
  .amdhsa_user_sgpr_kernarg_segment_ptr 1
  .amdhsa_system_sgpr_workgroup_id_x 1
.end_amdhsa_kernel
```
